```python
import torch

def _softmax(x, axis=-1):
    return torch.softmax(x, dim=axis)
def _gelu(x):
    return torch.nn.functional.gelu(x, approximate="tanh")
def _silu(x):
    return torch.nn.functional.silu(x)
def _sigmoid(x):
    return torch.sigmoid(x)
def _layernorm(x, axis=-1, eps=1e-5):
    m = x.mean(dim=axis, keepdim=True)
    v = x.var(dim=axis, keepdim=True, unbiased=False)
    return (x - m) / torch.sqrt(v + eps)
def _scatter_add(tgt, idx, src, axis=0):
    return tgt.clone().index_add_(axis, idx, src)
def _segment_sum(src, seg, n):
    out = torch.zeros((n,) + src.shape[1:], dtype=src.dtype)
    return out.index_add_(0, seg, src)
def _pad(x, pw):
    flat = tuple(v for pair in reversed(pw) for v in pair)
    return torch.nn.functional.pad(x, flat)

kernel_name = 'standalone__cheap_equivariant_egnn__graph'

def setup_inputs():

    _w = (lambda a: (lambda t: t.to(torch.bfloat16) if t.is_floating_point() else t)(torch.as_tensor(a)))
    N, deg, D, De = 10000, 64, 64, max(4, 1)
    E = N * deg
    return {
        "h": _w((lambda *s: torch.randn(*s, dtype=torch.bfloat16) * 0.2)(N, D)),
        "pos": _w((lambda *s: torch.randn(*s, dtype=torch.bfloat16) * 0.8)(N, 3)),
        "e_attr": _w((lambda *s: torch.randn(*s, dtype=torch.bfloat16) * 0.8)(E, De)),
        "src": _w((lambda lo, hi, *s: torch.randint(lo, hi, s))(0, N, E).to(torch.int64)),
        "dst": _w((lambda lo, hi, *s: torch.randint(lo, hi, s))(0, N, E).to(torch.int64)),
        "w_e": _w(0.1 * (lambda *s: torch.randn(*s, dtype=torch.bfloat16) * 0.8)(2 * D + 1 + De, D)),
        "w_x": _w(0.1 * (lambda *s: torch.randn(*s, dtype=torch.bfloat16) * 0.2)(D, 1)),
        "w_h": _w(0.1 * (lambda *s: torch.randn(*s, dtype=torch.bfloat16) * 0.2)(2 * D, D)),
    }

def reference(h, pos, e_attr, src, dst, w_e, w_x, w_h):
    N, D = h.shape[0], h.shape[1]
    diff = pos[dst] - pos[src]
    dist2 = torch.sum(diff * diff, axis=-1, keepdims=True)
    e_in = torch.concatenate([h[dst], h[src], dist2, e_attr], axis=-1)
    m_ij = _silu(e_in @ w_e)
    coord_scale = m_ij @ w_x
    pos_new = pos + _segment_sum(diff * coord_scale, dst, N)
    m_i = _segment_sum(m_ij, dst, N)
    h_new = h + _silu(torch.concatenate([h, m_i], axis=-1) @ w_h)
    return h_new, pos_new
```

```asm
; @launch grid=(256,1,1) block=(768,1,1) lds=163472
.amdgcn_target "amdgcn-amd-amdhsa--gfx950"
.text
.globl standalone__cheap_equivariant_egnn__graph_kernel
.p2align 8
.type standalone__cheap_equivariant_egnn__graph_kernel,@function
standalone__cheap_equivariant_egnn__graph_kernel:
    s_cmp_ge_u32 s2, 256
    s_cbranch_scc1 K2_EXIT
    s_load_dwordx4 s[8:11], s[0:1], 32
    s_load_dwordx4 s[4:7], s[0:1], 16
    s_load_dwordx2 s[90:91], s[0:1], 0
    s_load_dwordx2 s[94:95], s[0:1], 80
    s_load_dwordx2 s[92:93], s[0:1], 64
    s_getpc_b64 s[98:99]
K1_PC:
    v_lshlrev_b32 v6, 7, v0
    v_cmp_gt_u32 vcc, (K_HOT_END - K1_PC + 127) / 128, v0
    s_and_saveexec_b64 s[54:55], vcc
    s_cbranch_execz K1_NOCPF
    global_load_dword v166, v6, s[98:99]
K1_NOCPF:
    s_mov_b64 exec, -1
    v_lshrrev_b32 v6, 6, v0
    v_and_b32 v7, 63, v0
    v_lshlrev_b32 v1, 4, v0
    v_readfirstlane_b32 s52, v6
    v_mov_b32 v4, 0
    v_mov_b32 v5, 0
    s_cmp_ge_u32 s52, 10
    s_cbranch_scc1 K1_AUX
    v_lshlrev_b32 v2, 5, v0
    v_lshlrev_b32 v3, 3, v0
    s_mul_i32 s50, s2, 10000
    s_mul_i32 s51, s2, 20000
    ds_write_b64 v3, v[4:5] offset:0
    v_mov_b32 v25, 5120
    v_mov_b32 v26, 2500
    v_and_b32 v38, 15, v7
    v_lshlrev_b32 v39, 2, v38
    s_and_b32 s58, s2, 7
    s_lshl_b32 s58, s58, 5
    s_lshr_b32 s59, s2, 3
    s_add_u32 s58, s58, s59
    s_mul_i32 s58, s58, 625
    s_add_u32 s58, s58, 15
    s_lshr_b32 s58, s58, 4
    s_lshl_b32 s58, s58, 7
    v_lshrrev_b32 v33, 3, v7
    v_lshlrev_b32 v33, 4, v33
    v_xor_b32 v33, v33, v1
    v_subrev_u32 v33, 5120, v33
    s_cmp_lg_u32 s52, 0
    s_cbranch_scc1 K1_NW0
    ds_write_b32 v39, v4 offset:5376
    ds_write_b32 v25, v26 offset:0
K1_NW0:
    s_waitcnt lgkmcnt(0)
    s_mov_b32 s20, s8
    s_and_b32 s21, s9, 0xffff
    s_mov_b32 s22, 2560000
    s_mov_b32 s23, 0x00020000
    buffer_load_dwordx4 v[8:11], v1, s[20:23], s50 offen nt
    s_cmp_gt_u32 s52, 7
    s_cbranch_scc1 K1_NT2
    s_lshl_b32 s54, s52, 10
    s_add_u32 m0, s54, 137984
    s_movk_i32 s55, 8192
    s_mov_b32 s36, s10
    s_and_b32 s37, s11, 0xffff
    s_mov_b32 s38, 17024
    s_mov_b32 s39, 0x00020000
    buffer_load_dwordx4 v1, s[36:39], s55 offen lds
K1_NT2:
    s_cmp_lt_u32 s52, 5
    s_cbranch_scc1 K1_NHR
    s_lshl_b32 s54, s52, 10
    s_add_u32 m0, s54, 72960
    s_mov_b32 s40, s90
    s_and_b32 s41, s91, 0xffff
    s_mov_b32 s42, 1280000
    s_mov_b32 s43, 0x00020000
    buffer_load_dwordx4 v33, s[40:43], s58 offen lds
K1_NHR:
    s_mov_b32 s24, s6
    s_and_b32 s25, s7, 0xffff
    s_mov_b32 s26, 2560000
    s_mov_b32 s27, 0x00020000
    s_mov_b32 s28, s4
    s_and_b32 s29, s5, 0xffff
    s_mov_b32 s30, 5120000
    s_mov_b32 s31, 0x00020000
    s_barrier
    buffer_load_dwordx4 v[12:15], v1, s[24:27], s50 offen nt
    buffer_load_dwordx4 v[16:19], v2, s[28:31], s51 offen nt
    buffer_load_dwordx4 v[20:23], v2, s[28:31], s51 offen offset:16 nt
    s_mov_b32 s44, s94
    s_and_b32 s45, s95, 0xffff
    s_mov_b32 s46, 12222464
    s_mov_b32 s47, 0x00020000
    s_mov_b32 s56, 429497
    s_mov_b32 s57, 625
    v_mov_b32 v32, 1
    v_cmp_gt_u32 vcc, 625, v0
    s_mov_b64 s[62:63], vcc
    s_mov_b64 exec, s[62:63]
    s_waitcnt vmcnt(3)
    v_mul_u32_u24 v33, s56, v8
    v_lshrrev_b32 v33, 24, v33
    v_mad_u32_u24 v34, v33, s57, 15
    v_lshrrev_b32 v34, 4, v34
    v_sub_u32 v34, v8, v34
    v_lshrrev_b32 v35, 3, v34
    v_and_b32 v34, 7, v34
    v_mad_u32_u24 v24, v33, 5, v35
    v_lshlrev_b32 v24, 2, v24
    ds_add_rtn_u32 v28, v24, v32 offset:0
    v_lshl_or_b32 v8, v34, 3, v35
    v_mul_u32_u24 v33, s56, v9
    v_lshrrev_b32 v33, 24, v33
    v_mad_u32_u24 v34, v33, s57, 15
    v_lshrrev_b32 v34, 4, v34
    v_sub_u32 v34, v9, v34
    v_lshrrev_b32 v35, 3, v34
    v_and_b32 v34, 7, v34
    v_mad_u32_u24 v25, v33, 5, v35
    v_lshlrev_b32 v25, 2, v25
    ds_add_rtn_u32 v29, v25, v32 offset:0
    v_lshl_or_b32 v9, v34, 3, v35
    v_mul_u32_u24 v33, s56, v10
    v_lshrrev_b32 v33, 24, v33
    v_mad_u32_u24 v34, v33, s57, 15
    v_lshrrev_b32 v34, 4, v34
    v_sub_u32 v34, v10, v34
    v_lshrrev_b32 v35, 3, v34
    v_and_b32 v34, 7, v34
    v_mad_u32_u24 v26, v33, 5, v35
    v_lshlrev_b32 v26, 2, v26
    ds_add_rtn_u32 v30, v26, v32 offset:0
    v_lshl_or_b32 v10, v34, 3, v35
    v_mul_u32_u24 v33, s56, v11
    v_lshrrev_b32 v33, 24, v33
    v_mad_u32_u24 v34, v33, s57, 15
    v_lshrrev_b32 v34, 4, v34
    v_sub_u32 v34, v11, v34
    v_lshrrev_b32 v35, 3, v34
    v_and_b32 v34, 7, v34
    v_mad_u32_u24 v27, v33, 5, v35
    v_lshlrev_b32 v27, 2, v27
    ds_add_rtn_u32 v31, v27, v32 offset:0
    v_lshl_or_b32 v11, v34, 3, v35
    s_mov_b64 exec, -1
    s_waitcnt lgkmcnt(0)
    s_barrier
    ds_read_b64 v[34:35], v3 offset:0
    s_waitcnt lgkmcnt(0)
    v_add_u32 v36, v34, v35
    v_mov_b32 v37, v36
    s_nop 1
    v_add_u32_dpp v37, v37, v37 row_shr:1 row_mask:0xf bank_mask:0xf bound_ctrl:0
    s_nop 1
    v_add_u32_dpp v37, v37, v37 row_shr:2 row_mask:0xf bank_mask:0xf bound_ctrl:0
    s_nop 1
    v_add_u32_dpp v37, v37, v37 row_shr:4 row_mask:0xf bank_mask:0xf bound_ctrl:0
    s_nop 1
    v_add_u32_dpp v37, v37, v37 row_shr:8 row_mask:0xf bank_mask:0xf bound_ctrl:0
    s_nop 1
    v_add_u32_dpp v37, v37, v37 row_bcast:15 row_mask:0xa bank_mask:0xf
    s_nop 1
    v_add_u32_dpp v37, v37, v37 row_bcast:31 row_mask:0xc bank_mask:0xf
    s_nop 1
    s_lshl_b32 s58, s52, 2
    v_mov_b32 v40, s58
    s_mov_b32 exec_lo, 0
    s_mov_b32 exec_hi, 0x80000000
    ds_write_b32 v40, v37 offset:5376
    s_mov_b64 exec, -1
    v_cmp_gt_u32 vcc, s52, v38
    v_sub_u32 v37, v37, v36
    s_waitcnt lgkmcnt(0)
    s_barrier
    ds_read_b32 v39, v39 offset:5376
    s_waitcnt lgkmcnt(0)
    v_cndmask_b32 v39, 0, v39, vcc
    s_nop 1
    v_add_u32_dpp v39, v39, v39 row_shr:1 row_mask:0xf bank_mask:0xf bound_ctrl:0
    s_nop 1
    v_add_u32_dpp v39, v39, v39 row_shr:2 row_mask:0xf bank_mask:0xf bound_ctrl:0
    s_nop 1
    v_add_u32_dpp v39, v39, v39 row_shr:4 row_mask:0xf bank_mask:0xf bound_ctrl:0
    s_nop 1
    v_add_u32_dpp v39, v39, v39 row_shr:8 row_mask:0xf bank_mask:0xf bound_ctrl:0
    s_nop 1
    v_readlane_b32 s58, v39, 15
    s_nop 1
    v_add_u32 v36, s58, v37
    v_add_u32 v37, v36, v34
    ds_write_b64 v3, v[36:37] offset:0
    s_waitcnt lgkmcnt(0)
    s_barrier
    s_mov_b64 exec, s[62:63]
    ds_read_b32 v24, v24 offset:0
    ds_read_b32 v25, v25 offset:0
    ds_read_b32 v26, v26 offset:0
    ds_read_b32 v27, v27 offset:0
    s_mov_b64 exec, -1
    s_and_b32 s60, s2, 7
    s_lshl_b32 s60, s60, 5
    s_lshr_b32 s61, s2, 3
    s_add_u32 s60, s60, s61
    s_lshl_b32 s60, s60, 4
    s_lshl_b32 s64, s2, 12
    s_add_u32 s64, s64, 9043968
    s_add_u32 s60, s60, 7733248
    v_lshlrev_b32 v48, 12, v0
    s_cmp_gt_u32 s52, 3
    s_cbranch_scc1 K1_J1
    v_mul_u32_u24 v33, 20, v0
    ds_read2_b32 v[34:35], v33 offset0:0 offset1:1
    ds_read2_b32 v[36:37], v33 offset0:2 offset1:3
    ds_read2_b32 v[38:39], v33 offset0:4 offset1:5
    s_waitcnt lgkmcnt(0)
    v_sub_u32 v43, v39, v34
    v_sub_u32 v42, v39, v38
    v_sub_u32 v38, v38, v37
    v_sub_u32 v37, v37, v36
    v_sub_u32 v36, v36, v35
    v_sub_u32 v35, v35, v34
    v_cmp_lt_u32 vcc, 32, v43
    v_lshl_or_b32 v44, v43, 16, v34
    v_lshl_or_b32 v46, v36, 6, v35
    v_lshl_or_b32 v46, v37, 12, v46
    v_lshl_or_b32 v46, v38, 18, v46
    v_lshl_or_b32 v46, v42, 24, v46
    s_cbranch_vccnz K1_BIG
K1_J1:
    s_mov_b64 exec, s[62:63]
    s_waitcnt vmcnt(0) lgkmcnt(0)
    v_add_u32 v24, v24, v28
    v_mul_u32_u24 v24, 12, v24
    v_lshl_or_b32 v12, v12, 7, v8
    v_add_u32 v24, 5632, v24
    v_mul_u32_u24 v28, 12, v28
    v_lshl_or_b32 v12, v28, 21, v12
    ds_write_b32 v24, v12
    ds_write2_b32 v24, v16, v17 offset0:1 offset1:2
    v_add_u32 v25, v25, v29
    v_mul_u32_u24 v25, 12, v25
    v_lshl_or_b32 v13, v13, 7, v9
    v_add_u32 v25, 5632, v25
    v_mul_u32_u24 v29, 12, v29
    v_lshl_or_b32 v13, v29, 21, v13
    ds_write_b32 v25, v13
    ds_write2_b32 v25, v18, v19 offset0:1 offset1:2
    v_add_u32 v26, v26, v30
    v_mul_u32_u24 v26, 12, v26
    v_lshl_or_b32 v14, v14, 7, v10
    v_add_u32 v26, 5632, v26
    v_mul_u32_u24 v30, 12, v30
    v_lshl_or_b32 v14, v30, 21, v14
    ds_write_b32 v26, v14
    ds_write2_b32 v26, v20, v21 offset0:1 offset1:2
    v_add_u32 v27, v27, v31
    v_mul_u32_u24 v27, 12, v27
    v_lshl_or_b32 v15, v15, 7, v11
    v_add_u32 v27, 5632, v27
    v_mul_u32_u24 v31, 12, v31
    v_lshl_or_b32 v15, v31, 21, v15
    ds_write_b32 v27, v15
    ds_write2_b32 v27, v22, v23 offset0:1 offset1:2
    s_mov_b64 exec, -1
    s_mul_i32 s60, s2, 30080
    s_add_u32 s61, s60, 10240
    s_add_u32 s59, s60, 20480
    s_waitcnt lgkmcnt(0)
    s_barrier
    ds_read_b128 v[8:11], v1 offset:5632
    ds_read_b128 v[12:15], v1 offset:15872
    ds_read_b128 v[16:19], v1 offset:26112
    v_cmp_gt_u32 vcc, 600, v0
    s_waitcnt lgkmcnt(2)
    buffer_store_dwordx4 v[8:11], v1, s[44:47], s60 offen sc1
    s_waitcnt lgkmcnt(1)
    buffer_store_dwordx4 v[12:15], v1, s[44:47], s61 offen sc1
    s_and_saveexec_b64 s[54:55], vcc
    s_waitcnt lgkmcnt(0)
    buffer_store_dwordx4 v[16:19], v1, s[44:47], s59 offen sc1
    s_mov_b64 exec, -1
K1_PUB:
    v_mov_b32 v45, 163456
    ds_read_b32 v45, v45
    s_waitcnt vmcnt(0) lgkmcnt(0)
    s_barrier
    v_not_b32 v47, v45
    v_readfirstlane_b32 s88, v45
    s_cmp_gt_u32 s52, 3
    s_cbranch_scc1 K2_MAIN
    buffer_store_dwordx4 v[44:47], v1, s[44:47], s64 offen sc1
K2_MAIN:
    s_mov_b64 s[60:61], s[94:95]
    s_mov_b64 s[54:55], s[90:91]
    s_mov_b64 s[58:59], s[92:93]
    s_mov_b32 s25, s88
    v_lshrrev_b32 v152, 6, v0
    v_and_b32 v148, 63, v0
    v_and_b32 v149, 15, v0
    v_readfirstlane_b32 s28, v152
    s_and_b32 s3, s2, 7
    s_lshl_b32 s3, s3, 5
    s_lshr_b32 s2, s2, 3
    s_add_u32 s2, s2, s3
    s_mul_i32 s29, s2, 625
    s_add_u32 s30, s29, 640
    s_add_u32 s29, s29, 15
    s_lshr_b32 s29, s29, 4
    s_lshr_b32 s30, s30, 4
    s_sub_u32 s30, s30, s29
    s_mov_b32 s31, 0
    s_mov_b32 s46, 0
    s_mov_b32 s43, 256
    s_mov_b32 s50, -1
    s_mov_b32 s51, 0
    s_mov_b32 s52, 0
    s_mov_b32 s53, -1
    s_mov_b32 s49, 0x1fff80
    v_lshlrev_b32 v153, 4, v148
    s_mul_i32 s48, s28, 4160
    s_add_u32 s48, s48, 36480
    v_mov_b32 v2, 0
    v_mov_b32 v3, 0
    s_cmp_gt_u32 s28, 7
    s_cbranch_scc1 K2_HELP
    v_lshrrev_b32 v151, 4, v148
    s_and_b32 s56, s28, 3
    s_lshl_b32 s56, s56, 6
    s_lshr_b32 s57, s28, 2
    s_add_u32 s56, s56, s57
    s_lshl_b32 s56, s56, 12
    s_lshl_b32 s64, s2, 4
    s_add_u32 s64, s64, s56
    s_add_u32 s64, s64, 9043968
    v_bfe_u32 v120, v0, 3, 2
    v_and_b32 v121, 7, v0
    s_lshl_b32 s56, s28, 6
    s_add_u32 s56, s56, 40576
    v_lshl_add_u32 v123, v120, 9, s56
    v_lshl_add_u32 v123, v121, 3, v123
    s_lshl_b32 s56, s28, 2
    s_add_u32 s56, s56, 163168
    v_mov_b32 v124, s56
    v_mov_b32 v125, 1
    v_lshlrev_b32 v126, 2, v121
    v_add_u32 v126, 163168, v126
    v_lshlrev_b32 v120, 13, v120
    v_lshl_add_u32 v120, v121, 15, v120
    s_lshl_b32 s56, s28, 10
    s_add_u32 s56, s56, 86400
    v_lshl_add_u32 v121, v148, 2, s56
    v_lshl_add_u32 v122, v151, 5, s56
    s_mov_b32 s12, s60
    s_and_b32 s13, s61, 0xffff
    s_mov_b32 s14, 12222464
    s_mov_b32 s15, 0x00020000
    s_lshl_b32 s56, s28, 9
    s_add_u32 s56, s56, 36480
    v_lshl_add_u32 v159, v151, 4, s56
    s_and_b32 s56, s28, 3
    s_lshl_b32 s56, s56, 6
    s_lshr_b32 s57, s28, 2
    s_add_u32 s56, s56, s57
    v_lshl_add_u32 v158, v151, 1, s56
    v_mul_u32_u24 v158, 30080, v158
    v_mad_u32_u24 v158, v149, 12, v158
    v_add_lshl_u32 v152, v149, 17, 16
    v_add_lshl_u32 v149, v149, 1, 16
    s_mov_b32 s8, s54
    s_and_b32 s9, s55, 0xffff
    s_mov_b32 s10, 1280000
    s_mov_b32 s11, 0x00020000
    s_add_u32 s62, s60, 8781824
    s_addc_u32 s63, s61, 0
    s_mov_b32 s16, s62
    s_and_b32 s17, s63, 0xffff
    s_or_b32 s17, s17, 0x100000
    s_mov_b32 s18, 10000
    s_mov_b32 s19, 0x00020000
    s_mov_b32 s20, s58
    s_and_b32 s21, s59, 0xffff
    s_mov_b32 s22, 1340000
    s_mov_b32 s23, 0x00020000
    v_mov_b32 v4, 0
    v_mov_b32 v5, 0
    v_mov_b32 v6, 0
    v_mov_b32 v7, 0
    v_lshlrev_b32 v133, 4, v0
    v_add_u32 v133, 98688, v133
    ds_write_b128 v133, v[4:7] offset:0
    ds_write_b128 v133, v[4:7] offset:12288
    v_cmp_gt_u32 vcc, 408, v0
    s_and_saveexec_b64 s[54:55], vcc
    ds_write_b128 v133, v[4:7] offset:24576
    s_mov_b64 exec, s[54:55]
    v_and_b32 v135, 31, v0
    v_bfe_u32 v139, v0, 5, 1
    v_and_b32 v133, 7, v0
    v_lshlrev_b32 v134, 2, v139
    v_xor_b32 v133, v133, v134
    v_lshlrev_b32 v160, 4, v133
    v_and_b32 v133, 3, v135
    v_mul_u32_u24 v133, 1040, v133
    v_lshrrev_b32 v134, 2, v135
    v_lshl_add_u32 v133, v134, 7, v133
    v_lshl_add_u32 v133, v139, 4, v133
    v_add_u32 v133, s48, v133
    v_and_b32 v134, 4, v134
    v_lshl_add_u32 v161, v134, 4, v133
    v_xor_b32 v134, 4, v134
    v_lshl_add_u32 v162, v134, 4, v133
    s_mul_i32 s54, s28, 2592
    s_add_u32 s54, s54, 98688
    v_lshlrev_b32 v165, 3, v135
    v_add_u32 v165, s54, v165
    v_bfe_u32 v133, v0, 4, 1
    v_and_b32 v134, 3, v0
    v_lshl_add_u32 v133, v133, 2, v134
    v_mul_u32_u24 v133, 288, v133
    v_bfe_u32 v134, v0, 2, 2
    v_lshl_add_u32 v134, v139, 2, v134
    v_lshl_add_u32 v133, v134, 3, v133
    v_add_u32 v163, s54, v133
    v_and_b32 v12, 31, v0
    v_bfe_u32 v13, v0, 5, 1
    v_lshlrev_b32 v13, 3, v13
    v_sub_u32 v12, v12, v13
    v_mov_b32 v14, 0x3f80
    v_and_b32 v13, 1, v0
    v_lshlrev_b32 v13, 4, v13
    v_lshlrev_b32 v13, v13, v14
    v_ashrrev_i32 v12, 1, v12
    v_cmp_eq_u32 vcc, 0, v12
    v_cmp_eq_u32 s[56:57], 1, v12
    s_nop 0
    v_cndmask_b32 v4, 0, v13, vcc
    v_cndmask_b32 v5, 0, v13, s[56:57]
    v_cmp_eq_u32 vcc, 2, v12
    v_cmp_eq_u32 s[56:57], 3, v12
    s_nop 0
    v_cndmask_b32 v6, 0, v13, vcc
    v_cndmask_b32 v7, 0, v13, s[56:57]
    v_cmp_eq_u32 vcc, 8, v12
    v_cmp_eq_u32 s[56:57], 9, v12
    s_nop 0
    v_cndmask_b32 v8, 0, v13, vcc
    v_cndmask_b32 v9, 0, v13, s[56:57]
    v_cmp_eq_u32 vcc, 10, v12
    v_cmp_eq_u32 s[56:57], 11, v12
    s_nop 0
    v_cndmask_b32 v10, 0, v13, vcc
    v_cndmask_b32 v11, 0, v13, s[56:57]
    s_mov_b32 s89, 200000
    s_mov_b32 s56, -1
    s_not_b32 s63, s25
K2_CPOLL:
    s_mov_b32 exec_lo, s56
    s_mov_b32 exec_hi, 0
    buffer_load_dwordx4 v[116:119], v120, s[12:15], s64 offen sc1
    s_mov_b64 exec, -1
    s_waitcnt vmcnt(0)
    v_cmp_ne_u32 vcc, s25, v117
    v_cmp_ne_u32 s[56:57], s63, v119
    s_or_b32 s56, s56, vcc_lo
    s_cbranch_scc0 K2_CGO
    s_sub_u32 s89, s89, 1
    s_cbranch_scc1 K2_EXIT
    s_sleep 2
    s_branch K2_CPOLL
K2_CGO:
    ds_write_b32 v121, v116
    s_mov_b32 exec_hi, 0
    ds_write2_b32 v123, v116, v118 offset0:0 offset1:1
    s_mov_b32 exec_hi, -1
    ds_write_b32 v124, v125
    ds_read_b128 v[100:103], v122
    ds_read_b128 v[104:107], v122 offset:16
    s_waitcnt lgkmcnt(0)
    v_and_b32 v108, 0xffff, v100
    v_cmp_le_u32 s[68:69], v149, v100
    v_mad_u32_u24 v108, v108, 12, v158
    s_mov_b32 s54, 0
    s_or_b64 exec, s[68:69], 1
    buffer_load_dwordx3 v[36:38], v108, s[12:15], s54 offen sc1
    s_mov_b64 exec, -1
    v_and_b32 v109, 0xffff, v101
    v_cmp_le_u32 s[70:71], v149, v101
    v_mad_u32_u24 v109, v109, 12, v158
    s_mov_b32 s54, 240640
    s_or_b64 exec, s[70:71], 1
    buffer_load_dwordx3 v[40:42], v109, s[12:15], s54 offen sc1
    s_mov_b64 exec, -1
    v_and_b32 v110, 0xffff, v102
    v_cmp_le_u32 s[72:73], v149, v102
    v_mad_u32_u24 v110, v110, 12, v158
    s_mov_b32 s54, 481280
    s_or_b64 exec, s[72:73], 1
    buffer_load_dwordx3 v[44:46], v110, s[12:15], s54 offen sc1
    s_mov_b64 exec, -1
    v_and_b32 v111, 0xffff, v103
    v_cmp_le_u32 s[74:75], v149, v103
    v_mad_u32_u24 v111, v111, 12, v158
    s_mov_b32 s54, 721920
    s_or_b64 exec, s[74:75], 1
    buffer_load_dwordx3 v[48:50], v111, s[12:15], s54 offen sc1
    s_mov_b64 exec, -1
    v_and_b32 v112, 0xffff, v104
    v_cmp_le_u32 s[76:77], v149, v104
    v_mad_u32_u24 v112, v112, 12, v158
    s_mov_b32 s54, 962560
    s_or_b64 exec, s[76:77], 1
    buffer_load_dwordx3 v[52:54], v112, s[12:15], s54 offen sc1
    s_mov_b64 exec, -1
    v_and_b32 v113, 0xffff, v105
    v_cmp_le_u32 s[78:79], v149, v105
    v_mad_u32_u24 v113, v113, 12, v158
    s_mov_b32 s54, 1203200
    s_or_b64 exec, s[78:79], 1
    buffer_load_dwordx3 v[56:58], v113, s[12:15], s54 offen sc1
    s_mov_b64 exec, -1
    v_and_b32 v114, 0xffff, v106
    v_cmp_le_u32 s[80:81], v149, v106
    v_mad_u32_u24 v114, v114, 12, v158
    s_mov_b32 s54, 1443840
    s_or_b64 exec, s[80:81], 1
    buffer_load_dwordx3 v[60:62], v114, s[12:15], s54 offen sc1
    s_mov_b64 exec, -1
    v_and_b32 v115, 0xffff, v107
    v_cmp_le_u32 s[82:83], v149, v107
    v_mad_u32_u24 v115, v115, 12, v158
    s_mov_b32 s54, 1684480
    s_or_b64 exec, s[82:83], 1
    buffer_load_dwordx3 v[64:66], v115, s[12:15], s54 offen sc1
    s_mov_b64 exec, -1
    v_cmp_le_u32 s[84:85], v152, v100
    v_cmp_le_u32 s[86:87], v152, v101
    v_cmp_le_u32 s[88:89], v152, v102
    v_cmp_le_u32 s[90:91], v152, v103
    v_cmp_le_u32 s[92:93], v152, v104
    v_cmp_le_u32 s[94:95], v152, v105
    v_cmp_le_u32 s[96:97], v152, v106
    v_cmp_le_u32 s[98:99], v152, v107
    s_mov_b64 exec, s[84:85]
    s_cbranch_execnz K2_HI_LD0
K2_HI_LB0:
    s_mov_b64 exec, s[86:87]
    s_cbranch_execnz K2_HI_LD1
K2_HI_LB1:
    s_mov_b64 exec, s[88:89]
    s_cbranch_execnz K2_HI_LD2
K2_HI_LB2:
    s_mov_b64 exec, s[90:91]
    s_cbranch_execnz K2_HI_LD3
K2_HI_LB3:
    s_mov_b64 exec, s[92:93]
    s_cbranch_execnz K2_HI_LD4
K2_HI_LB4:
    s_mov_b64 exec, s[94:95]
    s_cbranch_execnz K2_HI_LD5
K2_HI_LB5:
    s_mov_b64 exec, s[96:97]
    s_cbranch_execnz K2_HI_LD6
K2_HI_LB6:
    s_mov_b64 exec, s[98:99]
    s_cbranch_execnz K2_HI_LD7
K2_HI_LB7:
    s_mov_b64 exec, -1
K2_POLL0:
    v_and_b32 v134, 31, v0
    v_lshlrev_b32 v134, 2, v134
    v_add_u32 v134, 163072, v134
    s_mov_b32 s55, 3200000
K2_POLL:
    s_sub_u32 s55, s55, 1
    s_cbranch_scc1 K2_EXIT
    ds_read_b32 v133, v134
    s_waitcnt lgkmcnt(0)
    v_cmp_eq_u32 vcc, 1, v133
    s_and_b32 s54, vcc_lo, 0xf0000
    s_cmp_eq_u32 s54, 0xf0000
    s_cbranch_scc1 K2_POLL_X
    s_sleep 1
    s_branch K2_POLL
K2_POLL_X:
    v_readlane_b32 s32, v133, 0
    v_readlane_b32 s33, v133, 1
    v_readlane_b32 s34, v133, 2
    v_readlane_b32 s35, v133, 3
    v_readlane_b32 s36, v133, 4
    v_readlane_b32 s37, v133, 5
    v_readlane_b32 s38, v133, 6
    v_readlane_b32 s39, v133, 7
    v_readlane_b32 s40, v133, 8
    v_readlane_b32 s41, v133, 9
    v_readlane_b32 s42, v133, 10
    s_cmp_lg_u32 s32, 0
    s_cbranch_scc1 K2_SLOW
    s_mul_i32 s54, s37, 5462
    s_lshr_b32 s54, s54, 16
    s_mul_i32 s55, s54, 12
    s_sub_u32 s55, s37, s55
    s_sub_u32 s55, 12, s55
    s_mul_i32 s44, s28, s54
    s_max_u32 s45, s28, s55
    s_sub_u32 s45, s45, s55
    s_add_u32 s44, s44, s45
    s_add_u32 s45, s44, s54
    s_cmp_ge_u32 s28, s55
    s_addc_u32 s45, s45, 0
    s_mul_i32 s54, s44, 384
    v_and_b32 v167, 31, v0
    v_mul_u32_u24 v167, 12, v167
    v_add_u32 v167, s54, v167
    v_lshrrev_b32 v166, 3, v148
    v_mul_u32_u24 v166, 48, v166
    v_add_u32 v166, s54, v166
    s_cmp_gt_u32 s28, 7
    s_cbranch_scc1 K2_HELP2
    s_waitcnt vmcnt(0)
    v_and_b32 v116, 7, v36
    v_lshl_add_u32 v116, v116, 1, v159
    ds_read_u16 v116, v116 offset:0
    v_and_b32 v117, 7, v40
    v_lshl_add_u32 v117, v117, 1, v159
    ds_read_u16 v117, v117 offset:64
    v_and_b32 v118, 7, v44
    v_lshl_add_u32 v118, v118, 1, v159
    ds_read_u16 v118, v118 offset:128
    v_and_b32 v119, 7, v48
    v_lshl_add_u32 v119, v119, 1, v159
    ds_read_u16 v119, v119 offset:192
    v_and_b32 v120, 7, v52
    v_lshl_add_u32 v120, v120, 1, v159
    ds_read_u16 v120, v120 offset:256
    v_and_b32 v121, 7, v56
    v_lshl_add_u32 v121, v121, 1, v159
    ds_read_u16 v121, v121 offset:320
    v_and_b32 v122, 7, v60
    v_lshl_add_u32 v122, v122, 1, v159
    ds_read_u16 v122, v122 offset:384
    v_and_b32 v123, 7, v64
    v_lshl_add_u32 v123, v123, 1, v159
    ds_read_u16 v123, v123 offset:448
    v_lshrrev_b32 v39, 21, v36
    v_lshrrev_b32 v43, 21, v40
    v_lshrrev_b32 v47, 21, v44
    v_lshrrev_b32 v51, 21, v48
    v_lshrrev_b32 v55, 21, v52
    v_lshrrev_b32 v59, 21, v56
    v_lshrrev_b32 v63, 21, v60
    v_lshrrev_b32 v67, 21, v64
    s_waitcnt lgkmcnt(7)
    v_mad_u32_u24 v116, v116, 12, v39
    s_waitcnt lgkmcnt(6)
    v_mad_u32_u24 v117, v117, 12, v43
    s_waitcnt lgkmcnt(5)
    v_mad_u32_u24 v118, v118, 12, v47
    s_waitcnt lgkmcnt(4)
    v_mad_u32_u24 v119, v119, 12, v51
    s_waitcnt lgkmcnt(3)
    v_mad_u32_u24 v120, v120, 12, v55
    s_waitcnt lgkmcnt(2)
    v_mad_u32_u24 v121, v121, 12, v59
    s_waitcnt lgkmcnt(1)
    v_mad_u32_u24 v122, v122, 12, v63
    s_waitcnt lgkmcnt(0)
    v_mad_u32_u24 v123, v123, 12, v67
    s_mov_b64 exec, s[68:69]
    ds_write_b32 v116, v36 offset:0
    ds_write2_b32 v116, v37, v38 offset0:1 offset1:2
    s_mov_b64 exec, s[70:71]
    ds_write_b32 v117, v40 offset:0
    ds_write2_b32 v117, v41, v42 offset0:1 offset1:2
    s_mov_b64 exec, s[72:73]
    ds_write_b32 v118, v44 offset:0
    ds_write2_b32 v118, v45, v46 offset0:1 offset1:2
    s_mov_b64 exec, s[74:75]
    ds_write_b32 v119, v48 offset:0
    ds_write2_b32 v119, v49, v50 offset0:1 offset1:2
    s_mov_b64 exec, s[76:77]
    ds_write_b32 v120, v52 offset:0
    ds_write2_b32 v120, v53, v54 offset0:1 offset1:2
    s_mov_b64 exec, s[78:79]
    ds_write_b32 v121, v56 offset:0
    ds_write2_b32 v121, v57, v58 offset0:1 offset1:2
    s_mov_b64 exec, s[80:81]
    ds_write_b32 v122, v60 offset:0
    ds_write2_b32 v122, v61, v62 offset0:1 offset1:2
    s_mov_b64 exec, s[82:83]
    ds_write_b32 v123, v64 offset:0
    ds_write2_b32 v123, v65, v66 offset0:1 offset1:2
    s_mov_b64 exec, s[84:85]
    s_cbranch_execnz K2_HI_ST0
K2_HI_SB0:
    s_mov_b64 exec, s[86:87]
    s_cbranch_execnz K2_HI_ST1
K2_HI_SB1:
    s_mov_b64 exec, s[88:89]
    s_cbranch_execnz K2_HI_ST2
K2_HI_SB2:
    s_mov_b64 exec, s[90:91]
    s_cbranch_execnz K2_HI_ST3
K2_HI_SB3:
    s_mov_b64 exec, s[92:93]
    s_cbranch_execnz K2_HI_ST4
K2_HI_SB4:
    s_mov_b64 exec, s[94:95]
    s_cbranch_execnz K2_HI_ST5
K2_HI_SB5:
    s_mov_b64 exec, s[96:97]
    s_cbranch_execnz K2_HI_ST6
K2_HI_SB6:
    s_mov_b64 exec, s[98:99]
    s_cbranch_execnz K2_HI_ST7
K2_HI_SB7:
    s_mov_b64 exec, -1
K2_CP_DONE:
    s_mov_b32 s65, 10092544
    s_waitcnt lgkmcnt(0)
    s_barrier
    s_cmp_ge_u32 s44, s45
    s_cbranch_scc1 K2_F_NOG
    ds_read2_b32 v[144:145], v166 offset0:0 offset1:3
    ds_read2_b32 v[146:147], v166 offset0:6 offset1:9
    ds_read_b32 v151, v167
    s_waitcnt lgkmcnt(0)
    v_and_or_b32 v144, v144, s49, v160
    v_and_or_b32 v145, v145, s49, v160
    v_and_or_b32 v146, v146, s49, v160
    v_and_or_b32 v147, v147, s49, v160
    s_mov_b32 m0, s48
    s_nop 0
    buffer_load_dwordx4 v144, s[12:15], s65 offen sc1 lds
    s_add_u32 m0, m0, 1040
    s_nop 0
    buffer_load_dwordx4 v145, s[12:15], s65 offen sc1 lds
    s_add_u32 m0, m0, 1040
    s_nop 0
    buffer_load_dwordx4 v146, s[12:15], s65 offen sc1 lds
    s_add_u32 m0, m0, 1040
    s_nop 0
    buffer_load_dwordx4 v147, s[12:15], s65 offen sc1 lds
    v_bfe_u32 v157, v151, 7, 14
    s_mov_b64 exec, s[52:53]
    buffer_load_dwordx3 v[148:150], v157, s[16:19], 0 idxen sc1
    s_mov_b64 exec, -1
K2_F_NOG:
    v_and_b32 v134, 63, v0
    s_mul_i32 s54, s37, 5462
    s_lshr_b32 s54, s54, 16
    s_mul_i32 s55, s54, 12
    s_sub_u32 s55, s37, s55
    s_sub_u32 s55, 12, s55
    v_max_u32 v132, s55, v134
    v_subrev_u32 v132, s55, v132
    v_mad_u32_u24 v132, v134, s54, v132
    v_add_u32 v134, 1, v134
    v_max_u32 v133, s55, v134
    v_subrev_u32 v133, s55, v133
    v_mad_u32_u24 v133, v134, s54, v133
    v_cmp_lt_u32 s[56:57], v132, v133
    s_mov_b64 s[4:5], 0
    s_mov_b32 s59, 0
    s_mov_b32 s24, s46
    v_cmp_lt_u32 s[68:69], s32, v133
    v_cmp_gt_u32 s[70:71], s33, v133
    v_cmp_lt_u32 s[72:73], s33, v133
    v_cmp_gt_u32 s[74:75], s34, v133
    v_cmp_lt_u32 s[76:77], s34, v133
    v_cmp_gt_u32 s[78:79], s35, v133
    v_cmp_lt_u32 s[80:81], s35, v133
    v_cmp_gt_u32 s[82:83], s36, v133
    v_cmp_lt_u32 s[84:85], s36, v133
    v_cmp_gt_u32 s[86:87], s37, v133
    s_and_b32 s56, s56, 0xfff
    s_mov_b64 s[98:99], 0
    v_cmp_gt_u32 vcc, s33, v132
    s_and_b32 s58, s68, s56
    s_and_b32 s58, s58, vcc_lo
    s_lshl_b64 s[62:63], s[58:59], 0
    s_or_b64 s[98:99], s[98:99], s[62:63]
    s_cmp_lg_u32 s38, 0
    s_cselect_b32 s58, 1, 0
    s_or_b32 s24, s24, s58
    s_and_b32 s58, s68, s70
    s_and_b32 s58, s58, s56
    s_lshl_b64 s[62:63], s[58:59], 0
    s_or_b64 s[4:5], s[4:5], s[62:63]
    v_cmp_gt_u32 vcc, s34, v132
    s_and_b32 s58, s72, s56
    s_and_b32 s58, s58, vcc_lo
    s_lshl_b64 s[62:63], s[58:59], 12
    s_or_b64 s[98:99], s[98:99], s[62:63]
    s_cmp_lg_u32 s39, 0
    s_cselect_b32 s58, 2, 0
    s_or_b32 s24, s24, s58
    s_and_b32 s58, s72, s74
    s_and_b32 s58, s58, s56
    s_lshl_b64 s[62:63], s[58:59], 12
    s_or_b64 s[4:5], s[4:5], s[62:63]
    v_cmp_gt_u32 vcc, s35, v132
    s_and_b32 s58, s76, s56
    s_and_b32 s58, s58, vcc_lo
    s_lshl_b64 s[62:63], s[58:59], 24
    s_or_b64 s[98:99], s[98:99], s[62:63]
    s_cmp_lg_u32 s40, 0
    s_cselect_b32 s58, 4, 0
    s_or_b32 s24, s24, s58
    s_and_b32 s58, s76, s78
    s_and_b32 s58, s58, s56
    s_lshl_b64 s[62:63], s[58:59], 24
    s_or_b64 s[4:5], s[4:5], s[62:63]
    v_cmp_gt_u32 vcc, s36, v132
    s_and_b32 s58, s80, s56
    s_and_b32 s58, s58, vcc_lo
    s_lshl_b64 s[62:63], s[58:59], 36
    s_or_b64 s[98:99], s[98:99], s[62:63]
    s_cmp_lg_u32 s41, 0
    s_cselect_b32 s58, 8, 0
    s_or_b32 s24, s24, s58
    s_and_b32 s58, s80, s82
    s_and_b32 s58, s58, s56
    s_lshl_b64 s[62:63], s[58:59], 36
    s_or_b64 s[4:5], s[4:5], s[62:63]
    v_cmp_gt_u32 vcc, s37, v132
    s_and_b32 s58, s84, s56
    s_and_b32 s58, s58, vcc_lo
    s_lshl_b64 s[62:63], s[58:59], 48
    s_or_b64 s[98:99], s[98:99], s[62:63]
    s_cmp_lg_u32 s42, 0
    s_cselect_b32 s58, 16, 0
    s_or_b32 s24, s24, s58
    s_and_b32 s58, s84, s86
    s_and_b32 s58, s58, s56
    s_lshl_b64 s[62:63], s[58:59], 48
    s_or_b64 s[4:5], s[4:5], s[62:63]
K2_F_M:
    s_cmp_ge_u32 s44, s45
    s_cbranch_scc1 K2_WAVE_DONE
    s_mov_b32 s6, 0
    s_mov_b32 s7, s33
    s_cmp_ge_u32 s44, s33
    s_cselect_b32 s6, 1, s6
    s_cselect_b32 s7, s34, s7
    s_cmp_ge_u32 s44, s34
    s_cselect_b32 s6, 2, s6
    s_cselect_b32 s7, s35, s7
    s_cmp_ge_u32 s44, s35
    s_cselect_b32 s6, 3, s6
    s_cselect_b32 s7, s36, s7
    s_cmp_ge_u32 s44, s36
    s_cselect_b32 s6, 4, s6
    s_cselect_b32 s7, s37, s7
    s_lshl_b32 s55, s6, 10
    s_add_u32 s55, s55, 155392
    s_lshl_b32 s56, s6, 7
    s_add_u32 s56, s56, 162048
    v_and_b32 v157, 31, v0
    v_lshlrev_b32 v157, 4, v157
    v_mov_b32 v164, 161536
    v_add_u32 v158, s55, v157
    s_mov_b64 exec, s[52:53]
    v_mov_b32 v164, s56
    v_add_u32 v158, 160512, v157
    s_mov_b64 exec, -1
    ds_read_b128 v[36:39], v158
    ds_read_b128 v[40:43], v158 offset:512
    s_mov_b32 s47, s6
    s_mov_b32 s3, s7
    s_mov_b64 vcc, -1
    s_mov_b32 s66, 0x30800000
    s_mov_b32 s67, 0x30800000
    v_and_b32 v157, 0x78, v151
    v_lshl_add_u32 v158, v157, 1, v164
    v_mad_u32_u24 v159, v157, 36, v165
    s_waitcnt vmcnt(0)
    ds_read_b128 v[108:111], v161
    ds_read_b128 v[112:115], v161 offset:32
    ds_read_b128 v[116:119], v162
    ds_read_b128 v[120:123], v162 offset:32
    ds_read2_b32 v[144:145], v166 offset0:96 offset1:99
    ds_read2_b32 v[146:147], v166 offset0:102 offset1:105
    ds_read_b32 v151, v167 offset:384
    s_mov_b64 exec, s[50:51]
    ds_read_b128 v[124:127], v158
    s_mov_b64 exec, s[52:53]
    ds_read2_b32 v[124:125], v167 offset0:1 offset1:2
    ds_read_b96 v[152:154], v158
    s_mov_b64 exec, -1
    v_add_u32 v166, 384, v166
    v_add_u32 v167, 384, v167
    s_cmp_eq_u32 s44, s44
    s_waitcnt lgkmcnt(0)
    s_cbranch_scc1 K2_NG0
    v_and_or_b32 v144, v144, s49, v160
    v_and_or_b32 v145, v145, s49, v160
    v_and_or_b32 v146, v146, s49, v160
    v_and_or_b32 v147, v147, s49, v160
    s_mov_b32 m0, s48
    s_nop 0
    buffer_load_dwordx4 v144, s[12:15], s65 offen sc1 lds
    s_add_u32 m0, m0, 1040
    s_nop 0
    buffer_load_dwordx4 v145, s[12:15], s65 offen sc1 lds
    s_add_u32 m0, m0, 1040
    s_nop 0
    buffer_load_dwordx4 v146, s[12:15], s65 offen sc1 lds
    s_add_u32 m0, m0, 1040
    s_nop 0
    buffer_load_dwordx4 v147, s[12:15], s65 offen sc1 lds
K2_NG0:
    s_mov_b64 exec, s[52:53]
    v_sub_f32 v152, v152, v148
    v_sub_f32 v153, v153, v149
    v_sub_f32 v154, v154, v150
    v_bfe_u32 v157, v151, 7, 14
    v_mul_f32 v155, v152, v152
    v_fmac_f32 v155, v153, v153
    v_fmac_f32 v155, v154, v154
    v_cvt_pk_bf16_f32 v127, v153, v154
    v_cvt_pk_bf16_f32 v156, 1.0, v152
    v_cvt_pk_bf16_f32 v126, v155, v155
    ds_write2_b32 v159, v156, v127 offset0:0 offset1:1
    s_cbranch_scc1 K2_NP0
    buffer_load_dwordx3 v[148:150], v157, s[16:19], 0 idxen sc1
K2_NP0:
    s_mov_b64 exec, -1
    v_mfma_f32_32x32x16_bf16 v[76:91], v[108:111], v[4:7], 0
    v_mfma_f32_32x32x16_bf16 v[76:91], v[112:115], v[8:11], v[76:91]
    v_mfma_f32_32x32x16_bf16 v[76:91], v[124:127], v[36:39], v[76:91]
    s_add_u32 s54, s44, 1
    s_cmp_ge_u32 s54, s45
    s_cbranch_scc1 K2_F_NOPF
    v_and_or_b32 v144, v144, s49, v160
    v_and_or_b32 v145, v145, s49, v160
    v_and_or_b32 v146, v146, s49, v160
    v_and_or_b32 v147, v147, s49, v160
    s_mov_b32 m0, s48
    s_nop 0
    buffer_load_dwordx4 v144, s[12:15], s65 offen sc1 lds
    s_add_u32 m0, m0, 1040
    s_nop 0
    buffer_load_dwordx4 v145, s[12:15], s65 offen sc1 lds
    s_add_u32 m0, m0, 1040
    s_nop 0
    buffer_load_dwordx4 v146, s[12:15], s65 offen sc1 lds
    s_add_u32 m0, m0, 1040
    s_nop 0
    buffer_load_dwordx4 v147, s[12:15], s65 offen sc1 lds
    s_mov_b64 exec, s[52:53]
    buffer_load_dwordx3 v[148:150], v157, s[16:19], 0 idxen sc1
    s_mov_b64 exec, -1
K2_F_NOPF:
    s_nop 3
K2_TILE:
    s_sub_u32 s54, s45, s44
    s_cmp_ge_u32 s54, 6
    s_cbranch_scc1 K2_PR3
    s_cmp_ge_u32 s54, 4
    s_cbranch_scc1 K2_PR2
    s_cmp_ge_u32 s54, 2
    s_cbranch_scc1 K2_PR1
    s_setprio 0
    s_branch K2_PRD
K2_PR1:
    s_setprio 1
    s_branch K2_PRD
K2_PR2:
    s_setprio 2
    s_branch K2_PRD
K2_PR3:
    s_setprio 3
K2_PRD:
    ds_read_b64_tr_b16 v[128:129], v163 offset:0
    ds_read_b64_tr_b16 v[130:131], v163 offset:64
    ds_read_b64_tr_b16 v[132:133], v163 offset:128
    ds_read_b64_tr_b16 v[134:135], v163 offset:192
    ds_write_b64 v159, v[2:3]
    s_add_u32 s44, s44, 1
    v_mfma_f32_32x32x16_bf16 v[92:107], v[116:119], v[4:7], 0
    v_exp_f32 v136, v76
    v_exp_f32 v137, v77
    v_exp_f32 v138, v78
    v_exp_f32 v139, v79
    v_exp_f32 v140, v80
    v_exp_f32 v141, v81
    v_exp_f32 v142, v82
    v_exp_f32 v143, v83
    v_pk_add_f32 v[136:137], v[136:137], 1.0 op_sel_hi:[1,0]
    v_pk_add_f32 v[138:139], v[138:139], 1.0 op_sel_hi:[1,0]
    v_pk_add_f32 v[140:141], v[140:141], 1.0 op_sel_hi:[1,0]
    v_pk_add_f32 v[142:143], v[142:143], 1.0 op_sel_hi:[1,0]
    v_mfma_f32_32x32x16_bf16 v[92:107], v[120:123], v[8:11], v[92:107]
    v_rcp_f32 v136, v136
    v_rcp_f32 v137, v137
    v_rcp_f32 v138, v138
    v_mfma_f32_32x32x16_bf16 v[92:107], v[124:127], v[40:43], v[92:107]
    v_rcp_f32 v139, v139
    v_rcp_f32 v140, v140
    v_rcp_f32 v141, v141
    v_rcp_f32 v142, v142
    v_rcp_f32 v143, v143
    v_pk_mul_f32 v[136:137], v[136:137], v[76:77]
    v_pk_mul_f32 v[138:139], v[138:139], v[78:79]
    v_pk_mul_f32 v[140:141], v[140:141], v[80:81]
    v_pk_mul_f32 v[142:143], v[142:143], v[82:83]
    v_cvt_pk_bf16_f32 v76, v136, v137
    v_cvt_pk_bf16_f32 v77, v138, v139
    v_cvt_pk_bf16_f32 v78, v140, v141
    v_cvt_pk_bf16_f32 v79, v142, v143
    s_waitcnt lgkmcnt(0)
    s_cmp_ge_u32 s44, s45
    s_cbranch_scc1 K2_A_NONEXT
    s_cmp_eq_u32 s44, s3
    s_cbranch_scc1 K2_A_NEWG
K2_A_SAMEG:
    v_and_b32 v157, 0x78, v151
    v_lshl_add_u32 v158, v157, 1, v164
    v_mad_u32_u24 v159, v157, 36, v165
    s_waitcnt vmcnt(0)
    ds_read_b128 v[108:111], v161
    ds_read_b128 v[112:115], v161 offset:32
    ds_read_b128 v[116:119], v162
    ds_read_b128 v[120:123], v162 offset:32
    ds_read2_b32 v[144:145], v166 offset0:96 offset1:99
    ds_read2_b32 v[146:147], v166 offset0:102 offset1:105
    ds_read_b32 v151, v167 offset:384
    s_mov_b64 exec, s[50:51]
    ds_read_b128 v[124:127], v158
    s_mov_b64 exec, s[52:53]
    ds_read2_b32 v[124:125], v167 offset0:1 offset1:2
    ds_read_b96 v[152:154], v158
    s_mov_b64 exec, -1
    v_add_u32 v166, 384, v166
    v_add_u32 v167, 384, v167
K2_A_NONEXT:
    v_exp_f32 v136, v84
    v_exp_f32 v137, v85
    v_exp_f32 v138, v86
    v_exp_f32 v139, v87
    v_exp_f32 v140, v88
    v_exp_f32 v141, v89
    v_exp_f32 v142, v90
    v_exp_f32 v143, v91
    v_pk_add_f32 v[136:137], v[136:137], 1.0 op_sel_hi:[1,0]
    v_pk_add_f32 v[138:139], v[138:139], 1.0 op_sel_hi:[1,0]
    v_pk_add_f32 v[140:141], v[140:141], 1.0 op_sel_hi:[1,0]
    v_pk_add_f32 v[142:143], v[142:143], 1.0 op_sel_hi:[1,0]
    s_cbranch_vccnz K2_Z0
    v_mfma_f32_32x32x16_bf16 v[44:59], v[128:131], v[76:79], v[44:59]
K2_ZB0:
    v_rcp_f32 v136, v136
    v_rcp_f32 v137, v137
    v_rcp_f32 v138, v138
    v_rcp_f32 v139, v139
    v_rcp_f32 v140, v140
    v_rcp_f32 v141, v141
    v_rcp_f32 v142, v142
    v_rcp_f32 v143, v143
    v_pk_mul_f32 v[136:137], v[136:137], v[84:85]
    v_pk_mul_f32 v[138:139], v[138:139], v[86:87]
    v_pk_mul_f32 v[140:141], v[140:141], v[88:89]
    v_pk_mul_f32 v[142:143], v[142:143], v[90:91]
    v_cvt_pk_bf16_f32 v80, v136, v137
    v_cvt_pk_bf16_f32 v81, v138, v139
    v_cvt_pk_bf16_f32 v82, v140, v141
    v_cvt_pk_bf16_f32 v83, v142, v143
    s_cmp_ge_u32 s44, s45
    s_waitcnt lgkmcnt(0)
    v_mfma_f32_32x32x16_bf16 v[44:59], v[132:135], v[80:83], v[44:59]
    s_cbranch_scc1 K2_B_NONEXT
    s_add_u32 s54, s44, 1
    s_cmp_ge_u32 s54, s45
    s_cbranch_scc1 K2_NG1
    v_and_or_b32 v144, v144, s49, v160
    v_and_or_b32 v145, v145, s49, v160
    v_and_or_b32 v146, v146, s49, v160
    v_and_or_b32 v147, v147, s49, v160
    s_mov_b32 m0, s48
    s_nop 0
    buffer_load_dwordx4 v144, s[12:15], s65 offen sc1 lds
    s_add_u32 m0, m0, 1040
    s_nop 0
    buffer_load_dwordx4 v145, s[12:15], s65 offen sc1 lds
    s_add_u32 m0, m0, 1040
    s_nop 0
    buffer_load_dwordx4 v146, s[12:15], s65 offen sc1 lds
    s_add_u32 m0, m0, 1040
    s_nop 0
    buffer_load_dwordx4 v147, s[12:15], s65 offen sc1 lds
K2_NG1:
    s_mov_b64 exec, s[52:53]
    v_sub_f32 v152, v152, v148
    v_sub_f32 v153, v153, v149
    v_sub_f32 v154, v154, v150
    v_bfe_u32 v157, v151, 7, 14
    v_mul_f32 v155, v152, v152
    v_fmac_f32 v155, v153, v153
    v_fmac_f32 v155, v154, v154
    v_cvt_pk_bf16_f32 v127, v153, v154
    v_cvt_pk_bf16_f32 v156, 1.0, v152
    v_cvt_pk_bf16_f32 v126, v155, v155
    ds_write2_b32 v159, v156, v127 offset0:0 offset1:1
    s_cbranch_scc1 K2_NP1
    buffer_load_dwordx3 v[148:150], v157, s[16:19], 0 idxen sc1
K2_NP1:
    s_mov_b64 exec, -1
K2_B_NONEXT:
    v_mfma_f32_32x32x16_bf16 v[76:91], v[108:111], v[4:7], 0
    v_exp_f32 v136, v92
    v_exp_f32 v137, v93
    v_exp_f32 v138, v94
    v_exp_f32 v139, v95
    v_exp_f32 v140, v96
    v_exp_f32 v141, v97
    v_exp_f32 v142, v98
    v_exp_f32 v143, v99
    v_pk_add_f32 v[136:137], v[136:137], 1.0 op_sel_hi:[1,0]
    v_pk_add_f32 v[138:139], v[138:139], 1.0 op_sel_hi:[1,0]
    v_pk_add_f32 v[140:141], v[140:141], 1.0 op_sel_hi:[1,0]
    v_pk_add_f32 v[142:143], v[142:143], 1.0 op_sel_hi:[1,0]
    v_mfma_f32_32x32x16_bf16 v[76:91], v[112:115], v[8:11], v[76:91]
    v_rcp_f32 v136, v136
    v_rcp_f32 v137, v137
    v_rcp_f32 v138, v138
    v_mfma_f32_32x32x16_bf16 v[76:91], v[124:127], v[36:39], v[76:91]
    v_rcp_f32 v139, v139
    v_rcp_f32 v140, v140
    v_rcp_f32 v141, v141
    v_rcp_f32 v142, v142
    v_rcp_f32 v143, v143
    v_pk_mul_f32 v[136:137], v[136:137], v[92:93]
    v_pk_mul_f32 v[138:139], v[138:139], v[94:95]
    v_pk_mul_f32 v[140:141], v[140:141], v[96:97]
    v_pk_mul_f32 v[142:143], v[142:143], v[98:99]
    v_cvt_pk_bf16_f32 v92, v136, v137
    v_cvt_pk_bf16_f32 v93, v138, v139
    v_cvt_pk_bf16_f32 v94, v140, v141
    v_cvt_pk_bf16_f32 v95, v142, v143
    v_exp_f32 v136, v100
    v_exp_f32 v137, v101
    v_exp_f32 v138, v102
    v_exp_f32 v139, v103
    v_exp_f32 v140, v104
    v_exp_f32 v141, v105
    v_exp_f32 v142, v106
    v_exp_f32 v143, v107
    v_pk_add_f32 v[136:137], v[136:137], 1.0 op_sel_hi:[1,0]
    v_pk_add_f32 v[138:139], v[138:139], 1.0 op_sel_hi:[1,0]
    v_pk_add_f32 v[140:141], v[140:141], 1.0 op_sel_hi:[1,0]
    v_pk_add_f32 v[142:143], v[142:143], 1.0 op_sel_hi:[1,0]
    s_cbranch_vccnz K2_Z1
    v_mfma_f32_32x32x16_bf16 v[60:75], v[128:131], v[92:95], v[60:75]
K2_ZB1:
    v_rcp_f32 v136, v136
    v_rcp_f32 v137, v137
    v_rcp_f32 v138, v138
    v_rcp_f32 v139, v139
    v_rcp_f32 v140, v140
    v_rcp_f32 v141, v141
    v_rcp_f32 v142, v142
    v_rcp_f32 v143, v143
    v_pk_mul_f32 v[136:137], v[136:137], v[100:101]
    v_pk_mul_f32 v[138:139], v[138:139], v[102:103]
    v_pk_mul_f32 v[140:141], v[140:141], v[104:105]
    v_pk_mul_f32 v[142:143], v[142:143], v[106:107]
    v_cvt_pk_bf16_f32 v96, v136, v137
    v_cvt_pk_bf16_f32 v97, v138, v139
    v_cvt_pk_bf16_f32 v98, v140, v141
    v_cvt_pk_bf16_f32 v99, v142, v143
    s_min_u32 s54, s3, s45
    s_cmp_lt_u32 s44, s54
    v_mfma_f32_32x32x16_bf16 v[60:75], v[132:135], v[96:99], v[60:75]
    s_cbranch_scc1 K2_TILE
    v_and_b32 v142, 31, v0
    v_lshlrev_b32 v142, 2, v142
    v_add_u32 v142, 161792, v142
    ds_read2_b32 v[140:141], v142 offset0:0 offset1:32
    s_mul_i32 s54, s47, 5120
    s_add_u32 s54, s54, 129792
    s_add_u32 s55, s54, 4096
    s_lshl_b32 s56, s28, 10
    s_add_u32 s56, s56, 86400
    s_lshr_b32 s57, s46, s47
    s_and_b32 s57, s57, 1
    s_cmp_eq_u32 s44, s3
    s_cselect_b32 s54, s54, s48
    s_cselect_b32 s55, s55, s56
    s_cselect_b32 s56, s57, 0
    v_and_b32 v142, 63, v0
    v_lshlrev_b32 v139, 2, v142
    v_lshlrev_b32 v142, 4, v142
    v_add_u32 v143, s55, v139
    v_add_u32 v139, s54, v139
    v_add_u32 v142, s54, v142
    s_cmp_lg_u32 s56, 0
    s_cbranch_scc1 K2_FL_RMW
K2_FL_W:
    ds_write2st64_b32 v139, v44, v48 offset0:12 offset1:13
    ds_write2st64_b32 v139, v52, v56 offset0:14 offset1:15
    ds_write2st64_b32 v143, v60, v64 offset0:0 offset1:1
    ds_write2st64_b32 v143, v68, v72 offset0:2 offset1:3
    s_waitcnt lgkmcnt(4)
    v_mul_f32 v92, v45, v140
    v_mul_f32 v93, v49, v140
    v_mul_f32 v94, v53, v140
    v_mul_f32 v95, v57, v140
    v_mul_f32 v96, v46, v140
    v_mul_f32 v97, v50, v140
    v_mul_f32 v98, v54, v140
    v_mul_f32 v99, v58, v140
    v_mul_f32 v100, v47, v140
    v_mul_f32 v101, v51, v140
    v_mul_f32 v102, v55, v140
    v_mul_f32 v103, v59, v140
    v_fmac_f32 v92, v61, v141
    v_fmac_f32 v93, v65, v141
    v_fmac_f32 v94, v69, v141
    v_fmac_f32 v95, v73, v141
    v_fmac_f32 v96, v62, v141
    v_fmac_f32 v97, v66, v141
    v_fmac_f32 v98, v70, v141
    v_fmac_f32 v99, v74, v141
    v_fmac_f32 v100, v63, v141
    v_fmac_f32 v101, v67, v141
    v_fmac_f32 v102, v71, v141
    v_fmac_f32 v103, v75, v141
    s_cmp_lg_u32 s56, 0
    s_cbranch_scc1 K2_FL_RMW2
K2_FL_W2:
    ds_write_b128 v142, v[92:95] offset:0
    ds_write_b128 v142, v[96:99] offset:1024
    ds_write_b128 v142, v[100:103] offset:2048
    s_mov_b32 s47, s6
    s_mov_b32 s3, s7
    s_mov_b64 vcc, -1
    s_cmp_lt_u32 s44, s45
    s_cbranch_scc1 K2_TILE
K2_WAVE_DONE:
    s_setprio 0
    v_and_b32 v140, 31, v0
    v_bfe_u32 v141, v0, 5, 1
    v_and_b32 v142, 63, v0
    v_lshlrev_b32 v153, 4, v142
    v_lshlrev_b32 v142, 2, v142
    s_mov_b32 s60, 0xbf317218
    s_mov_b32 s61, 98688
    s_cmp_lt_u32 s43, 256
    s_cbranch_scc1 K2_MID_BATCH
    s_lshl_b32 s54, s28, 2
    s_add_u32 s54, s54, 163392
    v_mov_b32 v129, s54
    v_mov_b32 v130, 1
    ds_write_b32 v129, v130
    s_lshr_b32 s55, s28, 2
    s_and_b32 s56, s28, 3
    s_lshl_b32 s57, s56, 12
    s_add_u32 s57, s57, 8945664
    s_lshl_b32 s58, s55, 4
    v_and_b32 v108, 15, v0
    v_add_u32 v108, s58, v108
    v_bfe_u32 v109, v0, 4, 2
    v_add_u32 v110, s29, v108
    v_lshlrev_b32 v110, 7, v110
    v_lshl_add_u32 v111, v109, 4, v110
    buffer_load_dwordx4 v[20:23], v111, s[8:11], 0 offen
    buffer_load_dwordx4 v[24:27], v111, s[8:11], 0 offen offset:64
    buffer_load_dwordx4 v[4:7], v153, s[12:15], s57 offen offset:0 sc1
    buffer_load_dwordx4 v[8:11], v153, s[12:15], s57 offen offset:1024 sc1
    buffer_load_dwordx4 v[12:15], v153, s[12:15], s57 offen offset:2048 sc1
    buffer_load_dwordx4 v[16:19], v153, s[12:15], s57 offen offset:3072 sc1
    s_lshl_b32 s58, s56, 5
    v_lshl_add_u32 v110, v109, 3, v110
    v_add_u32 v110, s58, v110
    buffer_load_dwordx2 v[28:29], v110, s[8:11], 0 offen
    v_lshrrev_b32 v111, 3, v108
    v_mul_u32_u24 v111, 2592, v111
    v_and_b32 v112, 7, v0
    v_mul_u32_u24 v112, 144, v112
    v_add3_u32 v111, v111, v112, s61
    v_lshl_add_u32 v111, v109, 4, v111
    v_lshlrev_b32 v112, 2, v140
    v_add_u32 v112, 163328, v112
    v_cmp_gt_u32 s[84:85], s30, v108
    s_lshl_b32 s86, s55, 1
    s_lshl_b32 s86, 0x300, s86
    s_and_b32 s86, s86, 0x1f00
    s_mov_b32 s62, 0xbfb8aa3b
    s_mov_b32 s61, s60
    s_cmp_lt_u32 s28, 5
    s_cbranch_scc1 K2_M_TASK
    s_cmp_lt_u32 s28, 9
    s_cbranch_scc1 K2_P_TASK
K2_G_TILE:
    s_waitcnt vmcnt(0)
K2_G_TILE2:
    v_mfma_f32_16x16x32_bf16 v[32:35], v[4:7], v[20:23], 0
    v_mfma_f32_16x16x32_bf16 v[32:35], v[8:11], v[24:27], v[32:35]
    v_lshlrev_b32 v36, 16, v28
    v_and_b32 v37, 0xffff0000, v28
    v_lshlrev_b32 v38, 16, v29
    v_and_b32 v39, 0xffff0000, v29
    s_mov_b32 s55, 12800000
K2_POLLG:
    s_sub_u32 s55, s55, 1
    s_cbranch_scc1 K2_EXIT
    ds_read_b32 v40, v112
    s_waitcnt lgkmcnt(0)
    v_cmp_eq_u32 vcc, 1, v40
    s_and_b32 s54, vcc_lo, s86
    s_cmp_eq_u32 s54, s86
    s_cbranch_scc1 K2_POLLXG
    s_sleep 1
    s_branch K2_POLLG
K2_POLLXG:
    ds_read_b128 v[20:23], v111
    ds_read_b128 v[24:27], v111 offset:64
    s_waitcnt lgkmcnt(1)
    v_mfma_f32_16x16x32_bf16 v[32:35], v[12:15], v[20:23], v[32:35]
    s_waitcnt lgkmcnt(0)
    v_mfma_f32_16x16x32_bf16 v[32:35], v[16:19], v[24:27], v[32:35]
    s_nop 7
    v_mul_f32 v40, s62, v32
    v_mul_f32 v41, s62, v33
    v_mul_f32 v42, s62, v34
    v_mul_f32 v43, s62, v35
    v_exp_f32 v40, v40
    v_exp_f32 v41, v41
    v_exp_f32 v42, v42
    v_exp_f32 v43, v43
    v_add_f32 v40, 1.0, v40
    v_add_f32 v41, 1.0, v41
    v_add_f32 v42, 1.0, v42
    v_add_f32 v43, 1.0, v43
    v_rcp_f32 v40, v40
    v_rcp_f32 v41, v41
    v_rcp_f32 v42, v42
    v_rcp_f32 v43, v43
    s_nop 0
    v_fmac_f32 v36, v32, v40
    v_fmac_f32 v37, v33, v41
    v_fmac_f32 v38, v34, v42
    v_fmac_f32 v39, v35, v43
    v_cvt_pk_bf16_f32 v40, v36, v37
    v_cvt_pk_bf16_f32 v41, v38, v39
    s_mov_b64 exec, s[84:85]
    buffer_store_dwordx2 v[40:41], v110, s[20:23], 0 offen
    s_mov_b64 exec, -1
    s_branch K2_END
K2_M_TASK:
    s_mov_b32 s71, s28
    s_mul_i32 s72, s71, 12
    s_lshr_b64 s[74:75], s[4:5], s72
    s_and_b32 s74, s74, 0xfff
    s_lshr_b64 s[76:77], s[98:99], s72
    s_and_b32 s87, s76, 0xfff
    s_lshl_b32 s87, s87, 16
    s_mul_i32 s73, s71, 5120
    s_lshl_b32 s77, s71, 3
    s_add_u32 s73, s73, 132864
    v_add_u32 v126, s73, v142
    s_mul_i32 s78, s71, 2592
    s_add_u32 s78, s78, 98688
    v_mul_u32_u24 v131, 144, v141
    v_lshl_add_u32 v131, v140, 1, v131
    v_add_u32 v131, s78, v131
    s_lshl_b32 s78, s71, 2
    s_add_u32 s78, s78, 163360
    v_mov_b32 v129, s78
    s_mov_b32 s79, 0
    s_cmp_eq_u32 s74, 0
    s_cbranch_scc1 K2_POPDM0
    s_ff1_i32_b32 s80, s74
    s_bitset0_b32 s74, s80
    s_mul_i32 s81, s80, 4160
    s_add_u32 s81, s81, 39552
    s_lshl_b32 s80, s80, 10
    s_add_u32 s80, s80, 86400
    v_add_u32 v120, s81, v142
    v_add_u32 v121, s80, v142
    s_mov_b32 s79, 1
    s_cmp_eq_u32 s74, 0
    s_cbranch_scc1 K2_POPDM0
    s_ff1_i32_b32 s80, s74
    s_bitset0_b32 s74, s80
    s_mul_i32 s81, s80, 4160
    s_add_u32 s81, s81, 39552
    s_lshl_b32 s80, s80, 10
    s_add_u32 s80, s80, 86400
    v_add_u32 v122, s81, v142
    v_add_u32 v123, s80, v142
    s_mov_b32 s79, 2
    s_cmp_eq_u32 s74, 0
    s_cbranch_scc1 K2_POPDM0
    s_ff1_i32_b32 s80, s74
    s_bitset0_b32 s74, s80
    s_mul_i32 s81, s80, 4160
    s_add_u32 s81, s81, 39552
    s_lshl_b32 s80, s80, 10
    s_add_u32 s80, s80, 86400
    v_add_u32 v124, s81, v142
    v_add_u32 v125, s80, v142
    s_mov_b32 s79, 3
K2_POPDM0:
    s_bitcmp0_b32 s24, s71
    s_cbranch_scc1 K2_M_ZERO
    s_mov_b32 s55, 12800000
K2_POLLM:
    s_sub_u32 s55, s55, 1
    s_cbranch_scc1 K2_EXIT
    ds_read_b32 v40, v112
    s_waitcnt lgkmcnt(0)
    v_cmp_eq_u32 vcc, 1, v40
    s_and_b32 s54, vcc_lo, s87
    s_cmp_eq_u32 s54, s87
    s_cbranch_scc1 K2_POLLXM
    s_sleep 1
    s_branch K2_POLLM
K2_POLLXM:
    s_setprio 3
    ds_read2st64_b32 v[44:45], v126 offset0:0 offset1:1
    ds_read2st64_b32 v[46:47], v126 offset0:2 offset1:3
    ds_read2st64_b32 v[48:49], v126 offset0:4 offset1:5
    ds_read2st64_b32 v[50:51], v126 offset0:6 offset1:7
K2_M_RD:
    s_cmp_le_u32 s79, 0
    s_cbranch_scc1 K2_M_ADD
    ds_read2st64_b32 v[52:53], v120 offset0:0 offset1:1
    ds_read2st64_b32 v[54:55], v120 offset0:2 offset1:3
    ds_read2st64_b32 v[56:57], v121 offset0:0 offset1:1
    ds_read2st64_b32 v[58:59], v121 offset0:2 offset1:3
    s_cmp_le_u32 s79, 1
    s_cbranch_scc1 K2_M_ADD
    ds_read2st64_b32 v[60:61], v122 offset0:0 offset1:1
    ds_read2st64_b32 v[62:63], v122 offset0:2 offset1:3
    ds_read2st64_b32 v[64:65], v123 offset0:0 offset1:1
    ds_read2st64_b32 v[66:67], v123 offset0:2 offset1:3
    s_cmp_le_u32 s79, 2
    s_cbranch_scc1 K2_M_ADD
    ds_read2st64_b32 v[68:69], v124 offset0:0 offset1:1
    ds_read2st64_b32 v[70:71], v124 offset0:2 offset1:3
    ds_read2st64_b32 v[72:73], v125 offset0:0 offset1:1
    ds_read2st64_b32 v[74:75], v125 offset0:2 offset1:3
K2_M_ADD:
    s_waitcnt lgkmcnt(0)
    s_cmp_le_u32 s79, 0
    s_cbranch_scc1 K2_M_FIN
    v_pk_add_f32 v[44:45], v[44:45], v[52:53]
    v_pk_add_f32 v[46:47], v[46:47], v[54:55]
    v_pk_add_f32 v[48:49], v[48:49], v[56:57]
    v_pk_add_f32 v[50:51], v[50:51], v[58:59]
    s_cmp_le_u32 s79, 1
    s_cbranch_scc1 K2_M_FIN
    v_pk_add_f32 v[44:45], v[44:45], v[60:61]
    v_pk_add_f32 v[46:47], v[46:47], v[62:63]
    v_pk_add_f32 v[48:49], v[48:49], v[64:65]
    v_pk_add_f32 v[50:51], v[50:51], v[66:67]
    s_cmp_le_u32 s79, 2
    s_cbranch_scc1 K2_M_FIN
    v_pk_add_f32 v[44:45], v[44:45], v[68:69]
    v_pk_add_f32 v[46:47], v[46:47], v[70:71]
    v_pk_add_f32 v[48:49], v[48:49], v[72:73]
    v_pk_add_f32 v[50:51], v[50:51], v[74:75]
    s_cmp_lg_u32 s74, 0
    s_cbranch_scc1 K2_M_MORE
K2_M_FIN:
    v_pk_mul_f32 v[44:45], v[44:45], s[60:61]
    v_pk_mul_f32 v[46:47], v[46:47], s[60:61]
    v_pk_mul_f32 v[48:49], v[48:49], s[60:61]
    v_pk_mul_f32 v[50:51], v[50:51], s[60:61]
    v_cvt_pk_bf16_f32 v44, v44, v48
    ds_write_b16 v131, v44 offset:0
    ds_write_b16_d16_hi v131, v44 offset:64
    v_cvt_pk_bf16_f32 v45, v45, v49
    ds_write_b16 v131, v45 offset:288
    ds_write_b16_d16_hi v131, v45 offset:352
    v_cvt_pk_bf16_f32 v46, v46, v50
    ds_write_b16 v131, v46 offset:576
    ds_write_b16_d16_hi v131, v46 offset:640
    v_cvt_pk_bf16_f32 v47, v47, v51
    ds_write_b16 v131, v47 offset:864
    ds_write_b16_d16_hi v131, v47 offset:928
    ds_write_b32 v129, v130
    s_setprio 0
    s_cmp_lg_u32 s28, 0
    s_cbranch_scc1 K2_G_TILE
    s_branch K2_P_TASK2
K2_P_TASK:
    s_sub_u32 s71, 9, s28
K2_P_TASK2:
    s_mul_i32 s72, s71, 12
    s_lshr_b64 s[74:75], s[4:5], s72
    s_and_b32 s74, s74, 0xfff
    s_lshr_b64 s[76:77], s[98:99], s72
    s_and_b32 s87, s76, 0xfff
    s_lshl_b32 s87, s87, 16
    s_mul_i32 s73, s71, 5120
    s_lshl_b32 s77, s71, 3
    v_bfe_u32 v128, v0, 3, 1
    v_and_b32 v119, 7, v0
    v_lshlrev_b32 v119, 4, v119
    v_lshl_add_u32 v119, v128, 9, v119
    v_lshl_add_u32 v119, v109, 10, v119
    v_and_b32 v117, 1, v109
    v_lshl_add_u32 v119, v117, 7, v119
    v_xor_b32 v117, 128, v119
    s_add_u32 s73, s73, 129792
    v_add_u32 v126, s73, v119
    v_add_u32 v127, s73, v117
    v_add_u32 v128, s77, v128
    v_lshlrev_b32 v129, 2, v128
    v_add_lshl_u32 v129, v129, v109, 2
    v_add_u32 v129, 162048, v129
    ds_read2_b32 v[132:133], v129 offset0:0 offset1:8
    ds_read2_b32 v[134:135], v129 offset0:16 offset1:24
    v_add_u32 v118, s29, v128
    v_mul_u32_u24 v118, 6, v118
    v_lshl_add_u32 v118, v109, 1, v118
    v_add_u32 v128, 6, v128
    v_cmp_gt_u32 s[64:65], s30, v128
    s_mov_b32 s79, 0
    s_cmp_eq_u32 s74, 0
    s_cbranch_scc1 K2_POPDP0
    s_ff1_i32_b32 s80, s74
    s_bitset0_b32 s74, s80
    s_mul_i32 s81, s80, 4160
    s_add_u32 s81, s81, 36480
    v_add_u32 v120, s81, v119
    v_add_u32 v121, s81, v117
    s_mov_b32 s79, 1
    s_cmp_eq_u32 s74, 0
    s_cbranch_scc1 K2_POPDP0
    s_ff1_i32_b32 s80, s74
    s_bitset0_b32 s74, s80
    s_mul_i32 s81, s80, 4160
    s_add_u32 s81, s81, 36480
    v_add_u32 v122, s81, v119
    v_add_u32 v123, s81, v117
    s_mov_b32 s79, 2
    s_cmp_eq_u32 s74, 0
    s_cbranch_scc1 K2_POPDP0
    s_ff1_i32_b32 s80, s74
    s_bitset0_b32 s74, s80
    s_mul_i32 s81, s80, 4160
    s_add_u32 s81, s81, 36480
    v_add_u32 v124, s81, v119
    v_add_u32 v125, s81, v117
    s_mov_b32 s79, 3
K2_POPDP0:
    s_mov_b32 s55, 12800000
K2_POLLP:
    s_sub_u32 s55, s55, 1
    s_cbranch_scc1 K2_EXIT
    ds_read_b32 v40, v112
    s_waitcnt lgkmcnt(0)
    v_cmp_eq_u32 vcc, 1, v40
    s_and_b32 s54, vcc_lo, s87
    s_cmp_eq_u32 s54, s87
    s_cbranch_scc1 K2_POLLXP
    s_sleep 1
    s_branch K2_POLLP
K2_POLLXP:
    ds_read_b128 v[44:47], v126
    ds_read_b128 v[48:51], v126 offset:256
    ds_read_b128 v[52:55], v127
    ds_read_b128 v[56:59], v127 offset:256
K2_P_RD:
    s_cmp_le_u32 s79, 0
    s_cbranch_scc1 K2_P_ADD
    ds_read_b128 v[60:63], v120
    ds_read_b128 v[64:67], v120 offset:256
    ds_read_b128 v[68:71], v121
    ds_read_b128 v[72:75], v121 offset:256
    s_cmp_le_u32 s79, 1
    s_cbranch_scc1 K2_P_ADD
    ds_read_b128 v[76:79], v122
    ds_read_b128 v[80:83], v122 offset:256
    ds_read_b128 v[84:87], v123
    ds_read_b128 v[88:91], v123 offset:256
    s_cmp_le_u32 s79, 2
    s_cbranch_scc1 K2_P_ADD
    ds_read_b128 v[92:95], v124
    ds_read_b128 v[96:99], v124 offset:256
    ds_read_b128 v[100:103], v125
    ds_read_b128 v[104:107], v125 offset:256
K2_P_ADD:
    s_waitcnt lgkmcnt(0)
    s_cmp_le_u32 s79, 0
    s_cbranch_scc1 K2_P_FIN
    v_pk_add_f32 v[44:45], v[44:45], v[60:61]
    v_pk_add_f32 v[46:47], v[46:47], v[62:63]
    v_pk_add_f32 v[48:49], v[48:49], v[64:65]
    v_pk_add_f32 v[50:51], v[50:51], v[66:67]
    v_pk_add_f32 v[52:53], v[52:53], v[68:69]
    v_pk_add_f32 v[54:55], v[54:55], v[70:71]
    v_pk_add_f32 v[56:57], v[56:57], v[72:73]
    v_pk_add_f32 v[58:59], v[58:59], v[74:75]
    s_cmp_le_u32 s79, 1
    s_cbranch_scc1 K2_P_FIN
    v_pk_add_f32 v[44:45], v[44:45], v[76:77]
    v_pk_add_f32 v[46:47], v[46:47], v[78:79]
    v_pk_add_f32 v[48:49], v[48:49], v[80:81]
    v_pk_add_f32 v[50:51], v[50:51], v[82:83]
    v_pk_add_f32 v[52:53], v[52:53], v[84:85]
    v_pk_add_f32 v[54:55], v[54:55], v[86:87]
    v_pk_add_f32 v[56:57], v[56:57], v[88:89]
    v_pk_add_f32 v[58:59], v[58:59], v[90:91]
    s_cmp_le_u32 s79, 2
    s_cbranch_scc1 K2_P_FIN
    v_pk_add_f32 v[44:45], v[44:45], v[92:93]
    v_pk_add_f32 v[46:47], v[46:47], v[94:95]
    v_pk_add_f32 v[48:49], v[48:49], v[96:97]
    v_pk_add_f32 v[50:51], v[50:51], v[98:99]
    v_pk_add_f32 v[52:53], v[52:53], v[100:101]
    v_pk_add_f32 v[54:55], v[54:55], v[102:103]
    v_pk_add_f32 v[56:57], v[56:57], v[104:105]
    v_pk_add_f32 v[58:59], v[58:59], v[106:107]
    s_cmp_lg_u32 s74, 0
    s_cbranch_scc1 K2_P_MORE
K2_P_FIN:
    s_bitcmp1_b32 s24, s71
    s_cbranch_scc0 K2_P_ST
    v_pk_add_f32 v[44:45], v[44:45], v[52:53]
    v_pk_add_f32 v[46:47], v[46:47], v[54:55]
    v_pk_add_f32 v[48:49], v[48:49], v[56:57]
    v_pk_add_f32 v[50:51], v[50:51], v[58:59]
    v_pk_add_f32 v[44:45], v[44:45], v[48:49]
    v_pk_add_f32 v[46:47], v[46:47], v[50:51]
    s_nop 1
    v_add_f32_dpp v44, v44, v44 row_shr:1 row_mask:0xf bank_mask:0xf bound_ctrl:0
    v_add_f32_dpp v45, v45, v45 row_shr:1 row_mask:0xf bank_mask:0xf bound_ctrl:0
    v_add_f32_dpp v46, v46, v46 row_shr:1 row_mask:0xf bank_mask:0xf bound_ctrl:0
    v_add_f32_dpp v47, v47, v47 row_shr:1 row_mask:0xf bank_mask:0xf bound_ctrl:0
    v_add_f32_dpp v44, v44, v44 row_shr:2 row_mask:0xf bank_mask:0xf bound_ctrl:0
    v_add_f32_dpp v45, v45, v45 row_shr:2 row_mask:0xf bank_mask:0xf bound_ctrl:0
    v_add_f32_dpp v46, v46, v46 row_shr:2 row_mask:0xf bank_mask:0xf bound_ctrl:0
    v_add_f32_dpp v47, v47, v47 row_shr:2 row_mask:0xf bank_mask:0xf bound_ctrl:0
    v_add_f32_dpp v44, v44, v44 row_shr:4 row_mask:0xf bank_mask:0xf bound_ctrl:0
    v_add_f32_dpp v45, v45, v45 row_shr:4 row_mask:0xf bank_mask:0xf bound_ctrl:0
    v_add_f32_dpp v46, v46, v46 row_shr:4 row_mask:0xf bank_mask:0xf bound_ctrl:0
    v_add_f32_dpp v47, v47, v47 row_shr:4 row_mask:0xf bank_mask:0xf bound_ctrl:0
    v_fmac_f32 v132, s60, v44
    v_fmac_f32 v133, s60, v45
    v_fmac_f32 v134, s60, v46
    v_fmac_f32 v135, s60, v47
K2_P_ST:
    s_mov_b32 s80, 1280000
    v_cvt_pk_bf16_f32 v132, v132, v133
    v_cvt_pk_bf16_f32 v134, v134, v135
    s_mov_b32 exec_lo, 0x80808080
    s_mov_b32 exec_hi, 0x8080
    buffer_store_short v132, v118, s[20:23], s80 offen
    buffer_store_short_d16_hi v132, v118, s[20:23], s80 offen offset:12
    buffer_store_short v134, v118, s[20:23], s80 offen offset:24
    s_and_b64 exec, exec, s[64:65]
    buffer_store_short_d16_hi v134, v118, s[20:23], s80 offen offset:36
    s_mov_b64 exec, -1
    s_waitcnt vmcnt(4)
    s_branch K2_G_TILE2
K2_END:
K2_EXIT:
    s_endpgm
K2_Z0:
    v_mfma_f32_32x32x16_bf16 v[44:59], v[128:131], v[76:79], 0
    s_branch K2_ZB0
K2_Z1:
    v_mfma_f32_32x32x16_bf16 v[60:75], v[128:131], v[92:95], 0
    s_mov_b64 vcc, 0
    s_branch K2_ZB1
K2_M_MORE:
    s_mov_b32 s79, 0
    s_cmp_eq_u32 s74, 0
    s_cbranch_scc1 K2_POPDM1
    s_ff1_i32_b32 s80, s74
    s_bitset0_b32 s74, s80
    s_mul_i32 s81, s80, 4160
    s_add_u32 s81, s81, 39552
    s_lshl_b32 s80, s80, 10
    s_add_u32 s80, s80, 86400
    v_add_u32 v120, s81, v142
    v_add_u32 v121, s80, v142
    s_mov_b32 s79, 1
    s_cmp_eq_u32 s74, 0
    s_cbranch_scc1 K2_POPDM1
    s_ff1_i32_b32 s80, s74
    s_bitset0_b32 s74, s80
    s_mul_i32 s81, s80, 4160
    s_add_u32 s81, s81, 39552
    s_lshl_b32 s80, s80, 10
    s_add_u32 s80, s80, 86400
    v_add_u32 v122, s81, v142
    v_add_u32 v123, s80, v142
    s_mov_b32 s79, 2
    s_cmp_eq_u32 s74, 0
    s_cbranch_scc1 K2_POPDM1
    s_ff1_i32_b32 s80, s74
    s_bitset0_b32 s74, s80
    s_mul_i32 s81, s80, 4160
    s_add_u32 s81, s81, 39552
    s_lshl_b32 s80, s80, 10
    s_add_u32 s80, s80, 86400
    v_add_u32 v124, s81, v142
    v_add_u32 v125, s80, v142
    s_mov_b32 s79, 3
K2_POPDM1:
    s_branch K2_M_RD
K2_P_MORE:
    s_mov_b32 s79, 0
    s_cmp_eq_u32 s74, 0
    s_cbranch_scc1 K2_POPDP1
    s_ff1_i32_b32 s80, s74
    s_bitset0_b32 s74, s80
    s_mul_i32 s81, s80, 4160
    s_add_u32 s81, s81, 36480
    v_add_u32 v120, s81, v119
    v_add_u32 v121, s81, v117
    s_mov_b32 s79, 1
    s_cmp_eq_u32 s74, 0
    s_cbranch_scc1 K2_POPDP1
    s_ff1_i32_b32 s80, s74
    s_bitset0_b32 s74, s80
    s_mul_i32 s81, s80, 4160
    s_add_u32 s81, s81, 36480
    v_add_u32 v122, s81, v119
    v_add_u32 v123, s81, v117
    s_mov_b32 s79, 2
    s_cmp_eq_u32 s74, 0
    s_cbranch_scc1 K2_POPDP1
    s_ff1_i32_b32 s80, s74
    s_bitset0_b32 s74, s80
    s_mul_i32 s81, s80, 4160
    s_add_u32 s81, s81, 36480
    v_add_u32 v124, s81, v119
    v_add_u32 v125, s81, v117
    s_mov_b32 s79, 3
K2_POPDP1:
    s_branch K2_P_RD
K2_HI_LD0:
    s_mov_b32 s54, 0
    buffer_load_dwordx3 v[68:70], v108, s[12:15], s54 offen offset:192 sc1
    s_branch K2_HI_LB0
K2_HI_LD1:
    s_mov_b32 s54, 240640
    buffer_load_dwordx3 v[72:74], v109, s[12:15], s54 offen offset:192 sc1
    s_branch K2_HI_LB1
K2_HI_LD2:
    s_mov_b32 s54, 481280
    buffer_load_dwordx3 v[76:78], v110, s[12:15], s54 offen offset:192 sc1
    s_branch K2_HI_LB2
K2_HI_LD3:
    s_mov_b32 s54, 721920
    buffer_load_dwordx3 v[80:82], v111, s[12:15], s54 offen offset:192 sc1
    s_branch K2_HI_LB3
K2_HI_LD4:
    s_mov_b32 s54, 962560
    buffer_load_dwordx3 v[84:86], v112, s[12:15], s54 offen offset:192 sc1
    s_branch K2_HI_LB4
K2_HI_LD5:
    s_mov_b32 s54, 1203200
    buffer_load_dwordx3 v[88:90], v113, s[12:15], s54 offen offset:192 sc1
    s_branch K2_HI_LB5
K2_HI_LD6:
    s_mov_b32 s54, 1443840
    buffer_load_dwordx3 v[92:94], v114, s[12:15], s54 offen offset:192 sc1
    s_branch K2_HI_LB6
K2_HI_LD7:
    s_mov_b32 s54, 1684480
    buffer_load_dwordx3 v[96:98], v115, s[12:15], s54 offen offset:192 sc1
    s_branch K2_HI_LB7
K2_HI_ST0:
    v_and_b32 v124, 7, v68
    v_lshl_add_u32 v124, v124, 1, v159
    ds_read_u16 v124, v124 offset:0
    v_lshrrev_b32 v71, 21, v68
    s_waitcnt lgkmcnt(0)
    v_mad_u32_u24 v124, v124, 12, v71
    ds_write_b32 v124, v68 offset:0
    ds_write2_b32 v124, v69, v70 offset0:1 offset1:2
    s_branch K2_HI_SB0
K2_HI_ST1:
    v_and_b32 v124, 7, v72
    v_lshl_add_u32 v124, v124, 1, v159
    ds_read_u16 v124, v124 offset:64
    v_lshrrev_b32 v75, 21, v72
    s_waitcnt lgkmcnt(0)
    v_mad_u32_u24 v124, v124, 12, v75
    ds_write_b32 v124, v72 offset:0
    ds_write2_b32 v124, v73, v74 offset0:1 offset1:2
    s_branch K2_HI_SB1
K2_HI_ST2:
    v_and_b32 v124, 7, v76
    v_lshl_add_u32 v124, v124, 1, v159
    ds_read_u16 v124, v124 offset:128
    v_lshrrev_b32 v79, 21, v76
    s_waitcnt lgkmcnt(0)
    v_mad_u32_u24 v124, v124, 12, v79
    ds_write_b32 v124, v76 offset:0
    ds_write2_b32 v124, v77, v78 offset0:1 offset1:2
    s_branch K2_HI_SB2
K2_HI_ST3:
    v_and_b32 v124, 7, v80
    v_lshl_add_u32 v124, v124, 1, v159
    ds_read_u16 v124, v124 offset:192
    v_lshrrev_b32 v83, 21, v80
    s_waitcnt lgkmcnt(0)
    v_mad_u32_u24 v124, v124, 12, v83
    ds_write_b32 v124, v80 offset:0
    ds_write2_b32 v124, v81, v82 offset0:1 offset1:2
    s_branch K2_HI_SB3
K2_HI_ST4:
    v_and_b32 v124, 7, v84
    v_lshl_add_u32 v124, v124, 1, v159
    ds_read_u16 v124, v124 offset:256
    v_lshrrev_b32 v87, 21, v84
    s_waitcnt lgkmcnt(0)
    v_mad_u32_u24 v124, v124, 12, v87
    ds_write_b32 v124, v84 offset:0
    ds_write2_b32 v124, v85, v86 offset0:1 offset1:2
    s_branch K2_HI_SB4
K2_HI_ST5:
    v_and_b32 v124, 7, v88
    v_lshl_add_u32 v124, v124, 1, v159
    ds_read_u16 v124, v124 offset:320
    v_lshrrev_b32 v91, 21, v88
    s_waitcnt lgkmcnt(0)
    v_mad_u32_u24 v124, v124, 12, v91
    ds_write_b32 v124, v88 offset:0
    ds_write2_b32 v124, v89, v90 offset0:1 offset1:2
    s_branch K2_HI_SB5
K2_HI_ST6:
    v_and_b32 v124, 7, v92
    v_lshl_add_u32 v124, v124, 1, v159
    ds_read_u16 v124, v124 offset:384
    v_lshrrev_b32 v95, 21, v92
    s_waitcnt lgkmcnt(0)
    v_mad_u32_u24 v124, v124, 12, v95
    ds_write_b32 v124, v92 offset:0
    ds_write2_b32 v124, v93, v94 offset0:1 offset1:2
    s_branch K2_HI_SB6
K2_HI_ST7:
    v_and_b32 v124, 7, v96
    v_lshl_add_u32 v124, v124, 1, v159
    ds_read_u16 v124, v124 offset:448
    v_lshrrev_b32 v99, 21, v96
    s_waitcnt lgkmcnt(0)
    v_mad_u32_u24 v124, v124, 12, v99
    ds_write_b32 v124, v96 offset:0
    ds_write2_b32 v124, v97, v98 offset0:1 offset1:2
    s_branch K2_HI_SB7
K2_HELP:
    s_sub_u32 s57, s28, 8
    s_lshl_b32 s56, s57, 2
    s_add_u32 s56, s56, 163136
    v_mov_b32 v150, s56
    s_mov_b32 s12, s60
    s_and_b32 s13, s61, 0xffff
    s_mov_b32 s14, 12222464
    s_mov_b32 s15, 0x00020000
    s_mov_b32 s8, s54
    s_and_b32 s9, s55, 0xffff
    s_mov_b32 s10, 1280000
    s_mov_b32 s11, 0x00020000
    s_add_u32 s62, s60, 8781824
    s_addc_u32 s63, s61, 0
    s_mov_b32 s16, s62
    s_and_b32 s17, s63, 0xffff
    s_or_b32 s17, s17, 0x100000
    s_mov_b32 s18, 10000
    s_mov_b32 s19, 0x00020000
    s_mov_b32 s20, s58
    s_and_b32 s21, s59, 0xffff
    s_mov_b32 s22, 1340000
    s_mov_b32 s23, 0x00020000
    v_mov_b32 v4, 0
    v_mov_b32 v5, 0
    v_mov_b32 v6, 0
    v_mov_b32 v7, 0
    v_lshlrev_b32 v133, 4, v0
    v_add_u32 v133, 98688, v133
    ds_write_b128 v133, v[4:7] offset:0
    ds_write_b128 v133, v[4:7] offset:12288
    v_cmp_gt_u32 vcc, 408, v0
    s_and_saveexec_b64 s[54:55], vcc
    ds_write_b128 v133, v[4:7] offset:24576
    s_mov_b64 exec, s[54:55]
    v_and_b32 v135, 31, v0
    v_bfe_u32 v139, v0, 5, 1
    v_and_b32 v133, 7, v0
    v_lshlrev_b32 v134, 2, v139
    v_xor_b32 v133, v133, v134
    v_lshlrev_b32 v160, 4, v133
    v_and_b32 v133, 3, v135
    v_mul_u32_u24 v133, 1040, v133
    v_lshrrev_b32 v134, 2, v135
    v_lshl_add_u32 v133, v134, 7, v133
    v_lshl_add_u32 v133, v139, 4, v133
    v_add_u32 v133, s48, v133
    v_and_b32 v134, 4, v134
    v_lshl_add_u32 v161, v134, 4, v133
    v_xor_b32 v134, 4, v134
    v_lshl_add_u32 v162, v134, 4, v133
    s_mul_i32 s54, s28, 2592
    s_add_u32 s54, s54, 98688
    v_lshlrev_b32 v165, 3, v135
    v_add_u32 v165, s54, v165
    v_bfe_u32 v133, v0, 4, 1
    v_and_b32 v134, 3, v0
    v_lshl_add_u32 v133, v133, 2, v134
    v_mul_u32_u24 v133, 288, v133
    v_bfe_u32 v134, v0, 2, 2
    v_lshl_add_u32 v134, v139, 2, v134
    v_lshl_add_u32 v133, v134, 3, v133
    v_add_u32 v163, s54, v133
    v_and_b32 v12, 31, v0
    v_bfe_u32 v13, v0, 5, 1
    v_lshlrev_b32 v13, 3, v13
    v_sub_u32 v12, v12, v13
    v_mov_b32 v14, 0x3f80
    v_and_b32 v13, 1, v0
    v_lshlrev_b32 v13, 4, v13
    v_lshlrev_b32 v13, v13, v14
    v_ashrrev_i32 v12, 1, v12
    v_cmp_eq_u32 vcc, 0, v12
    v_cmp_eq_u32 s[56:57], 1, v12
    s_nop 0
    v_cndmask_b32 v4, 0, v13, vcc
    v_cndmask_b32 v5, 0, v13, s[56:57]
    v_cmp_eq_u32 vcc, 2, v12
    v_cmp_eq_u32 s[56:57], 3, v12
    s_nop 0
    v_cndmask_b32 v6, 0, v13, vcc
    v_cndmask_b32 v7, 0, v13, s[56:57]
    v_cmp_eq_u32 vcc, 8, v12
    v_cmp_eq_u32 s[56:57], 9, v12
    s_nop 0
    v_cndmask_b32 v8, 0, v13, vcc
    v_cndmask_b32 v9, 0, v13, s[56:57]
    v_cmp_eq_u32 vcc, 10, v12
    v_cmp_eq_u32 s[56:57], 11, v12
    s_nop 0
    v_cndmask_b32 v10, 0, v13, vcc
    v_cndmask_b32 v11, 0, v13, s[56:57]
    s_cmp_eq_u32 s28, 8
    s_cbranch_scc1 K2_H8
    s_cmp_eq_u32 s28, 10
    s_cbranch_scc1 K2_H10
    s_cmp_lg_u32 s28, 11
    s_cbranch_scc1 K2_H9
    v_lshlrev_b32 v60, 16, v60
    v_lshlrev_b32 v61, 16, v61
    v_lshlrev_b32 v62, 16, v62
    v_mov_b32 v63, 0
    v_add_u32 v52, 162048, v153
    ds_write_b128 v52, v[60:63]
K2_H9:
    s_bfe_u32 s56, s28, 0x10001
    s_lshl_b32 s57, s56, 6
    s_add_u32 s57, s57, 146176
    v_bfe_u32 v52, v0, 2, 2
    v_bfe_u32 v53, v0, 5, 1
    v_lshl_add_u32 v52, v53, 3, v52
    v_lshlrev_b32 v52, 7, v52
    v_bfe_u32 v53, v0, 4, 1
    v_lshl_add_u32 v52, v53, 5, v52
    v_and_b32 v53, 3, v0
    v_lshl_add_u32 v52, v53, 3, v52
    v_add_u32 v52, s57, v52
    ds_read_b64_tr_b16 v[36:37], v52 offset:0
    ds_read_b64_tr_b16 v[38:39], v52 offset:512
    ds_read_b64_tr_b16 v[40:41], v52 offset:2048
    ds_read_b64_tr_b16 v[42:43], v52 offset:2560
    ds_read_b64_tr_b16 v[44:45], v52 offset:4096
    ds_read_b64_tr_b16 v[46:47], v52 offset:4608
    ds_read_b64_tr_b16 v[48:49], v52 offset:6144
    ds_read_b64_tr_b16 v[50:51], v52 offset:6656
    v_bfe_u32 v54, v0, 5, 1
    v_bfe_u32 v55, v0, 2, 1
    v_bfe_u32 v56, v0, 4, 1
    v_lshl_add_u32 v55, v55, 1, v56
    v_bfe_u32 v56, v0, 3, 1
    v_and_b32 v57, 3, v0
    v_lshl_add_u32 v56, v56, 2, v57
    v_lshl_add_u32 v55, v55, 3, v56
    v_lshlrev_b32 v55, 7, v55
    v_add_u32 v55, 78080, v55
    v_xor_b32 v56, v56, v54
    v_xor_b32 v65, 2, v56
    v_xor_b32 v66, 4, v56
    v_xor_b32 v67, 6, v56
    v_lshl_add_u32 v64, v56, 4, v55
    v_lshl_add_u32 v65, v65, 4, v55
    v_lshl_add_u32 v66, v66, 4, v55
    v_lshl_add_u32 v67, v67, 4, v55
    s_waitcnt lgkmcnt(4)
    ds_read_b128 v[68:71], v64 offset:0
    ds_read_b128 v[72:75], v65 offset:0
    ds_read_b128 v[76:79], v66 offset:0
    ds_read_b128 v[80:83], v67 offset:0
    ds_read_b128 v[84:87], v64 offset:4096
    ds_read_b128 v[88:91], v65 offset:4096
    ds_read_b128 v[92:95], v66 offset:4096
    ds_read_b128 v[96:99], v67 offset:4096
    s_mov_b32 s58, 0xbfb8aa3b
    s_lshl_b32 s59, s56, 9
    s_add_u32 s59, s59, 155392
    v_and_b32 v56, 31, v0
    v_lshlrev_b32 v54, 11, v54
    v_lshl_add_u32 v56, v56, 4, v54
    v_add_u32 v56, s59, v56
    s_waitcnt lgkmcnt(7)
    v_mfma_f32_32x32x16_bf16 v[100:115], v[68:71], v[36:39], 0
    s_waitcnt lgkmcnt(6)
    v_mfma_f32_32x32x16_bf16 v[100:115], v[72:75], v[40:43], v[100:115]
    s_waitcnt lgkmcnt(5)
    v_mfma_f32_32x32x16_bf16 v[100:115], v[76:79], v[44:47], v[100:115]
    s_waitcnt lgkmcnt(4)
    v_mfma_f32_32x32x16_bf16 v[100:115], v[80:83], v[48:51], v[100:115]
    s_waitcnt lgkmcnt(3)
    v_mfma_f32_32x32x16_bf16 v[116:131], v[84:87], v[36:39], 0
    s_waitcnt lgkmcnt(2)
    v_mfma_f32_32x32x16_bf16 v[116:131], v[88:91], v[40:43], v[116:131]
    s_waitcnt lgkmcnt(1)
    v_mfma_f32_32x32x16_bf16 v[116:131], v[92:95], v[44:47], v[116:131]
    s_waitcnt lgkmcnt(0)
    v_mfma_f32_32x32x16_bf16 v[116:131], v[96:99], v[48:51], v[116:131]
    s_nop 3
    v_mul_f32 v100, s58, v100
    v_mul_f32 v101, s58, v101
    v_mul_f32 v102, s58, v102
    v_mul_f32 v103, s58, v103
    v_mul_f32 v104, s58, v104
    v_mul_f32 v105, s58, v105
    v_mul_f32 v106, s58, v106
    v_mul_f32 v107, s58, v107
    v_mul_f32 v108, s58, v108
    v_mul_f32 v109, s58, v109
    v_mul_f32 v110, s58, v110
    v_mul_f32 v111, s58, v111
    v_mul_f32 v112, s58, v112
    v_mul_f32 v113, s58, v113
    v_mul_f32 v114, s58, v114
    v_mul_f32 v115, s58, v115
    v_mul_f32 v116, s58, v116
    v_mul_f32 v117, s58, v117
    v_mul_f32 v118, s58, v118
    v_mul_f32 v119, s58, v119
    v_mul_f32 v120, s58, v120
    v_mul_f32 v121, s58, v121
    v_mul_f32 v122, s58, v122
    v_mul_f32 v123, s58, v123
    v_cvt_pk_bf16_f32 v68, v100, v101
    v_cvt_pk_bf16_f32 v69, v102, v103
    v_cvt_pk_bf16_f32 v70, v104, v105
    v_cvt_pk_bf16_f32 v71, v106, v107
    v_cvt_pk_bf16_f32 v72, v108, v109
    v_cvt_pk_bf16_f32 v73, v110, v111
    v_cvt_pk_bf16_f32 v74, v112, v113
    v_cvt_pk_bf16_f32 v75, v114, v115
    v_cvt_pk_bf16_f32 v76, v116, v117
    v_cvt_pk_bf16_f32 v77, v118, v119
    v_cvt_pk_bf16_f32 v78, v120, v121
    v_cvt_pk_bf16_f32 v79, v122, v123
    ds_write_b128 v56, v[68:71]
    ds_write_b128 v56, v[72:75] offset:1024
    s_mov_b32 exec_hi, 0
    ds_write_b128 v56, v[76:79] offset:4096
    s_mov_b64 exec, -1
    s_branch K2_H2
K2_H10:
    s_mov_b32 s58, 0xbfb8aa3b
    v_lshlrev_b32 v60, 16, v60
    v_lshlrev_b32 v61, 16, v61
    v_lshlrev_b32 v62, 16, v62
    v_lshlrev_b32 v63, 16, v63
    v_lshlrev_b32 v64, 16, v64
    v_lshlrev_b32 v65, 16, v65
    v_mul_f32 v60, s58, v60
    v_mul_f32 v61, s58, v61
    v_mul_f32 v62, s58, v62
    v_mul_f32 v63, s58, v63
    v_mul_f32 v64, s58, v64
    v_cvt_pk_bf16_f32 v56, v61, v62
    v_cvt_pk_bf16_f32 v57, v63, v64
    v_cvt_pk_bf16_f32 v58, v60, v2
    v_lshlrev_b32 v59, 16, v58
    v_sub_f32 v59, v60, v59
    v_cvt_pk_bf16_f32 v58, v60, v59
    v_mov_b32 v59, 0
    v_add_u32 v53, 160512, v153
    v_lshrrev_b32 v60, 2, v148
    v_and_b32 v61, 3, v148
    v_lshlrev_b32 v61, 1, v61
    v_sub_u32 v60, v60, v61
    v_mov_b32 v62, 0x3f80
    v_mov_b32 v63, 0x3f800000
    v_cmp_eq_u32 vcc, 0, v60
    v_cmp_eq_u32 s[56:57], 1, v60
    v_lshlrev_b32 v54, 2, v148
    v_cndmask_b32 v61, 0, v62, vcc
    v_cndmask_b32 v61, v61, v63, s[56:57]
    v_cndmask_b32 v61, 0, v61, s[50:51]
    v_add_u32 v54, 161536, v54
    ds_write_b128 v53, v[56:59]
    ds_write2st64_b32 v54, v61, v65 offset0:0 offset1:1
    s_branch K2_H2
K2_H8:
    s_setprio 2
    s_mov_b32 s89, 3200000
    v_and_b32 v152, 7, v0
    v_lshlrev_b32 v152, 2, v152
    v_add_u32 v152, 163168, v152
    v_lshlrev_b32 v92, 3, v148
    v_add_u32 v92, 40576, v92
K2_HWAIT:
    ds_read_b32 v132, v152
    s_waitcnt lgkmcnt(0)
    v_cmp_ne_u32 vcc, 1, v132
    s_cbranch_vccz K2_HGO
    s_sub_u32 s89, s89, 1
    s_cbranch_scc1 K2_EXIT
    s_sleep 1
    s_branch K2_HWAIT
K2_HGO:
    ds_read_b64 v[76:77], v92
    ds_read_b64 v[80:81], v92 offset:512
    ds_read_b64 v[84:85], v92 offset:1024
    ds_read_b64 v[88:89], v92 offset:1536
    s_waitcnt lgkmcnt(0)
    s_mov_b32 s55, 0x3f0000
    v_and_b32 v116, 63, v77
    v_lshlrev_b32 v119, 10, v77
    v_and_or_b32 v116, v119, s55, v116
    v_bfe_u32 v117, v77, 12, 6
    v_lshrrev_b32 v119, 2, v77
    v_and_or_b32 v117, v119, s55, v117
    v_bfe_u32 v118, v77, 24, 6
    v_and_b32 v120, 63, v81
    v_lshlrev_b32 v123, 10, v81
    v_and_or_b32 v120, v123, s55, v120
    v_bfe_u32 v121, v81, 12, 6
    v_lshrrev_b32 v123, 2, v81
    v_and_or_b32 v121, v123, s55, v121
    v_bfe_u32 v122, v81, 24, 6
    v_and_b32 v124, 63, v85
    v_lshlrev_b32 v127, 10, v85
    v_and_or_b32 v124, v127, s55, v124
    v_bfe_u32 v125, v85, 12, 6
    v_lshrrev_b32 v127, 2, v85
    v_and_or_b32 v125, v127, s55, v125
    v_bfe_u32 v126, v85, 24, 6
    v_and_b32 v128, 63, v89
    v_lshlrev_b32 v131, 10, v89
    v_and_or_b32 v128, v131, s55, v128
    v_bfe_u32 v129, v89, 12, 6
    v_lshrrev_b32 v131, 2, v89
    v_and_or_b32 v129, v131, s55, v129
    v_bfe_u32 v130, v89, 24, 6
    v_max3_u32 v135, v76, v80, v84
    v_max_u32 v135, v135, v88
    s_mov_b32 s54, 2162688
    v_add_u32 v120, v120, v116
    v_add_u32 v121, v121, v117
    v_add_u32 v122, v122, v118
    v_cmp_le_u32 s[56:57], s54, v135
    v_add_u32 v124, v124, v120
    v_add_u32 v125, v125, v121
    v_add_u32 v126, v126, v122
    v_add_u32 v128, v128, v124
    v_add_u32 v129, v129, v125
    v_add_u32 v130, v130, v126
    v_mov_b32 v136, v128
    v_mov_b32 v137, v129
    v_mov_b32 v138, v130
    s_nop 1
    v_add_u32_dpp v136, v136, v136 row_shr:1 row_mask:0xf bank_mask:0xf bound_ctrl:0
    v_add_u32_dpp v137, v137, v137 row_shr:1 row_mask:0xf bank_mask:0xf bound_ctrl:0
    v_add_u32_dpp v138, v138, v138 row_shr:1 row_mask:0xf bank_mask:0xf bound_ctrl:0
    v_add_u32_dpp v136, v136, v136 row_shr:2 row_mask:0xf bank_mask:0xf bound_ctrl:0
    v_add_u32_dpp v137, v137, v137 row_shr:2 row_mask:0xf bank_mask:0xf bound_ctrl:0
    v_add_u32_dpp v138, v138, v138 row_shr:2 row_mask:0xf bank_mask:0xf bound_ctrl:0
    v_add_u32_dpp v136, v136, v136 row_shr:4 row_mask:0xf bank_mask:0xf bound_ctrl:0
    v_add_u32_dpp v137, v137, v137 row_shr:4 row_mask:0xf bank_mask:0xf bound_ctrl:0
    v_add_u32_dpp v138, v138, v138 row_shr:4 row_mask:0xf bank_mask:0xf bound_ctrl:0
    v_add_u32_dpp v136, v136, v136 row_shr:8 row_mask:0xf bank_mask:0xf bound_ctrl:0
    v_add_u32_dpp v137, v137, v137 row_shr:8 row_mask:0xf bank_mask:0xf bound_ctrl:0
    v_add_u32_dpp v138, v138, v138 row_shr:8 row_mask:0xf bank_mask:0xf bound_ctrl:0
    v_add_u32_dpp v136, v136, v136 row_bcast:15 row_mask:0xa bank_mask:0xf
    v_add_u32_dpp v137, v137, v137 row_bcast:15 row_mask:0xa bank_mask:0xf
    v_add_u32_dpp v138, v138, v138 row_bcast:15 row_mask:0xa bank_mask:0xf
    v_add_u32_dpp v136, v136, v136 row_bcast:31 row_mask:0xc bank_mask:0xf
    v_add_u32_dpp v137, v137, v137 row_bcast:31 row_mask:0xc bank_mask:0xf
    v_add_u32_dpp v138, v138, v138 row_bcast:31 row_mask:0xc bank_mask:0xf
    v_lshlrev_b32 v132, 6, v148
    v_readlane_b32 s54, v136, 63
    v_readlane_b32 s55, v137, 63
    v_readlane_b32 s42, v138, 63
    v_sub_u32 v136, v136, v128
    v_sub_u32 v137, v137, v129
    v_sub_u32 v138, v138, v130
    s_and_b32 s38, s54, 0xffff
    s_lshr_b32 s39, s54, 16
    s_and_b32 s40, s55, 0xffff
    s_lshr_b32 s41, s55, 16
    s_mov_b32 s32, 0
    s_add_u32 s54, s38, 31
    s_lshr_b32 s54, s54, 5
    s_add_u32 s33, s32, s54
    s_add_u32 s54, s39, 31
    s_lshr_b32 s54, s54, 5
    s_add_u32 s34, s33, s54
    s_add_u32 s54, s40, 31
    s_lshr_b32 s54, s54, 5
    s_add_u32 s35, s34, s54
    s_add_u32 s54, s41, 31
    s_lshr_b32 s54, s54, 5
    s_add_u32 s36, s35, s54
    s_add_u32 s54, s42, 31
    s_lshr_b32 s54, s54, 5
    s_add_u32 s37, s36, s54
    s_lshl_b32 s54, s33, 21
    s_lshl_b32 s55, s35, 21
    s_lshl_b32 s58, s34, 5
    s_add_u32 s55, s55, s58
    s_lshl_b32 s58, s36, 5
    v_add_u32 v136, s54, v136
    v_add_u32 v137, s55, v137
    v_add_u32 v138, s58, v138
    v_add_u32 v132, 36480, v132
    v_add_u32 v116, v116, v136
    v_add_u32 v117, v117, v137
    v_add_u32 v118, v118, v138
    v_add_u32 v120, v120, v136
    v_add_u32 v121, v121, v137
    v_add_u32 v122, v122, v138
    v_add_u32 v124, v124, v136
    v_add_u32 v125, v125, v137
    v_add_u32 v126, v126, v138
    ds_write_b96 v132, v[136:138]
    ds_write_b96 v132, v[116:118] offset:16
    ds_write_b96 v132, v[120:122] offset:32
    ds_write_b96 v132, v[124:126] offset:48
    s_cmp_gt_u32 s37, 95
    s_cselect_b32 s54, 1, 0
    s_cmp_lg_u64 s[56:57], 0
    s_cselect_b32 s54, 1, s54
    v_mov_b32 v133, s54
    v_writelane_b32 v133, s33, 1
    v_writelane_b32 v133, s34, 2
    v_writelane_b32 v133, s35, 3
    v_writelane_b32 v133, s36, 4
    v_writelane_b32 v133, s37, 5
    v_writelane_b32 v133, s38, 6
    v_writelane_b32 v133, s39, 7
    v_writelane_b32 v133, s40, 8
    v_writelane_b32 v133, s41, 9
    v_writelane_b32 v133, s42, 10
    v_lshlrev_b32 v134, 2, v148
    v_add_u32 v134, 163072, v134
    s_mov_b64 exec, 0xffff
    ds_write_b32 v134, v133
    s_mov_b64 exec, -1
K2_H2:
    v_mov_b32 v152, 1
    ds_write_b32 v150, v152
    s_branch K2_POLL0
K2_HELP2:
    s_cmp_lg_u32 s28, 11
    s_cbranch_scc1 K2_HELP3
    v_mov_b32 v133, 64
    v_and_b32 v134, 31, v0
    s_lshl_b32 s54, s32, 5
    s_add_u32 s54, s54, s38
    s_lshl_b32 s55, s33, 5
    s_add_u32 s55, s55, s39
    s_lshl_b32 s56, s33, 5
    s_lshl_b32 s57, s34, 5
    v_add_u32 v132, s54, v134
    v_add_u32 v135, s55, v134
    v_cmp_gt_u32 vcc, s56, v132
    v_cmp_gt_u32 s[58:59], s57, v135
    v_cndmask_b32 v132, v132, v135, s[52:53]
    v_mul_u32_u24 v132, 12, v132
    s_mov_b32 exec_lo, vcc_lo
    s_mov_b32 exec_hi, s59
    ds_write_b32 v132, v133 offset:0
    ds_write2_b32 v132, v2, v2 offset0:1 offset1:2
    s_mov_b64 exec, -1
    s_lshl_b32 s54, s34, 5
    s_add_u32 s54, s54, s40
    s_lshl_b32 s55, s35, 5
    s_add_u32 s55, s55, s41
    s_lshl_b32 s56, s35, 5
    s_lshl_b32 s57, s36, 5
    v_add_u32 v132, s54, v134
    v_add_u32 v135, s55, v134
    v_cmp_gt_u32 vcc, s56, v132
    v_cmp_gt_u32 s[58:59], s57, v135
    v_cndmask_b32 v132, v132, v135, s[52:53]
    v_mul_u32_u24 v132, 12, v132
    s_mov_b32 exec_lo, vcc_lo
    s_mov_b32 exec_hi, s59
    ds_write_b32 v132, v133 offset:0
    ds_write2_b32 v132, v2, v2 offset0:1 offset1:2
    s_mov_b64 exec, -1
    s_lshl_b32 s54, s36, 5
    s_add_u32 s54, s54, s42
    s_lshl_b32 s55, s36, 5
    s_add_u32 s55, s55, s42
    s_lshl_b32 s56, s37, 5
    s_lshl_b32 s57, s37, 5
    v_add_u32 v132, s54, v134
    v_add_u32 v135, s55, v134
    v_cmp_gt_u32 vcc, s56, v132
    v_cmp_gt_u32 s[58:59], s57, v135
    v_cndmask_b32 v132, v132, v135, s[52:53]
    v_mul_u32_u24 v132, 12, v132
    s_mov_b32 exec_lo, vcc_lo
    s_mov_b32 exec_hi, s59
    ds_write_b32 v132, v133 offset:0
    ds_write2_b32 v132, v2, v2 offset0:1 offset1:2
    s_mov_b64 exec, -1
K2_HELP3:
    s_setprio 0
    s_waitcnt vmcnt(0)
    s_branch K2_CP_DONE
K2_M_ZERO:
    v_mov_b32 v44, 0
    v_mov_b32 v45, 0
    v_mov_b32 v46, 0
    v_mov_b32 v47, 0
    v_mov_b32 v48, 0
    v_mov_b32 v49, 0
    v_mov_b32 v50, 0
    v_mov_b32 v51, 0
    s_branch K2_M_FIN
K2_A_NEWG:
    s_mov_b32 s6, 0
    s_mov_b32 s7, s33
    s_cmp_ge_u32 s44, s33
    s_cselect_b32 s6, 1, s6
    s_cselect_b32 s7, s34, s7
    s_cmp_ge_u32 s44, s34
    s_cselect_b32 s6, 2, s6
    s_cselect_b32 s7, s35, s7
    s_cmp_ge_u32 s44, s35
    s_cselect_b32 s6, 3, s6
    s_cselect_b32 s7, s36, s7
    s_cmp_ge_u32 s44, s36
    s_cselect_b32 s6, 4, s6
    s_cselect_b32 s7, s37, s7
    s_lshl_b32 s55, s6, 10
    s_add_u32 s55, s55, 155392
    s_lshl_b32 s56, s6, 7
    s_add_u32 s56, s56, 162048
    v_and_b32 v157, 31, v0
    v_lshlrev_b32 v157, 4, v157
    v_mov_b32 v164, 161536
    v_add_u32 v158, s55, v157
    s_mov_b64 exec, s[52:53]
    v_mov_b32 v164, s56
    v_add_u32 v158, 160512, v157
    s_mov_b64 exec, -1
    ds_read_b128 v[36:39], v158
    ds_read_b128 v[40:43], v158 offset:512
    s_branch K2_A_SAMEG
K1_BIG:
    v_lshl_or_b32 v40, v36, 16, v35
    v_lshl_or_b32 v41, v38, 16, v37
    v_mov_b32 v43, v44
    s_mov_b64 exec, vcc
    buffer_store_dwordx4 v[40:43], v48, s[44:47], s60 offen sc1
    s_mov_b64 exec, -1
    s_branch K1_J1
K1_AUX:
    s_load_dwordx2 s[96:97], s[0:1], 72
    s_memrealtime s[80:81]
    v_lshlrev_b32 v48, 1, v7
    v_lshlrev_b32 v49, 4, v7
    v_and_b32 v51, 15, v7
    v_lshlrev_b32 v51, 2, v51
    v_add_u32 v51, 163136, v51
    ds_write_b32 v51, v4
    ds_write2_b32 v51, v4, v4 offset0:48 offset1:64
    s_movk_i32 s75, 4096
    s_and_b32 s76, s2, 7
    s_lshl_b32 s76, s76, 5
    s_lshr_b32 s77, s2, 3
    s_add_u32 s76, s76, s77
    s_mul_i32 s76, s76, 625
    s_add_u32 s79, s76, 640
    s_lshr_b32 s79, s79, 4
    s_add_u32 s76, s76, 15
    s_lshr_b32 s76, s76, 4
    s_sub_u32 s79, s79, s76
    s_lshl_b32 s77, s76, 7
    s_mul_i32 s76, s76, 6
    s_cmp_eq_u32 s52, 11
    s_cbranch_scc1 K1_AUXB
    s_load_dwordx2 s[16:17], s[0:1], 8
    s_load_dwordx2 s[14:15], s[0:1], 56
    s_load_dwordx2 s[48:49], s[0:1], 48
    s_barrier
    s_waitcnt lgkmcnt(0)
    s_mov_b32 s36, s10
    s_and_b32 s37, s11, 0xffff
    s_mov_b32 s38, 17024
    s_mov_b32 s39, 0x00020000
    s_mov_b32 s44, s94
    s_and_b32 s45, s95, 0xffff
    s_mov_b32 s46, 12222464
    s_mov_b32 s47, 0x00020000
    s_mov_b32 s40, s14
    s_and_b32 s41, s15, 0xffff
    s_mov_b32 s42, 16384
    s_mov_b32 s43, 0x00020000
    s_and_b32 s76, s2, 7
    s_lshl_b32 s76, s76, 3
    v_lshrrev_b32 v50, 3, v7
    v_add_u32 v50, s76, v50
    v_and_b32 v52, 7, v7
    v_lshrrev_b32 v51, 4, v50
    v_lshl_add_u32 v52, v51, 3, v52
    v_and_b32 v51, 15, v50
    s_bfe_u32 s76, s2, 0x20003
    s_lshl_b32 s76, s76, 5
    s_bfe_u32 s77, s2, 0x20005
    s_lshl_b32 s77, s77, 4
    v_add_u32 v52, s76, v52
    v_add_u32 v51, s77, v51
    v_lshl_add_u32 v52, v52, 6, v51
    v_lshlrev_b32 v52, 1, v52
    buffer_load_ushort v52, v52, s[40:43], 0 offen
    s_lshl_b32 s60, s2, 7
    s_add_u32 s60, s60, 8945664
    s_mov_b32 s89, 200000
    s_branch K1_BP
K1_AUXB:
    s_cmp_gt_u32 s2, 7
    s_cbranch_scc1 K1_NOTOK
    s_waitcnt lgkmcnt(0)
    s_or_b32 s80, s80, 1
    v_mov_b32 v52, s80
    v_mov_b32 v53, 0
    s_mov_b64 exec, 1
    global_atomic_cmpswap v4, v[52:53], s[96:97] sc1
    s_mov_b64 exec, -1
K1_NOTOK:
    s_load_dwordx2 s[16:17], s[0:1], 8
    s_load_dwordx2 s[48:49], s[0:1], 48
    s_barrier
    s_waitcnt lgkmcnt(0)
    s_mov_b32 s36, s10
    s_and_b32 s37, s11, 0xffff
    s_mov_b32 s38, 17024
    s_mov_b32 s39, 0x00020000
    s_mov_b32 s44, s94
    s_and_b32 s45, s95, 0xffff
    s_mov_b32 s46, 12222464
    s_mov_b32 s47, 0x00020000
    s_mov_b32 s32, s16
    s_and_b32 s33, s17, 0xffff
    s_mov_b32 s34, 60000
    s_mov_b32 s35, 0x00020000
    v_mul_u32_u24 v51, 6, v7
    s_mul_i32 s74, s2, 240
    buffer_load_ushort v56, v51, s[32:35], s74 offen
    buffer_load_ushort v57, v51, s[32:35], s74 offen offset:2
    buffer_load_ushort v58, v51, s[32:35], s74 offen offset:4
    s_mul_i32 s59, s2, 640
    s_add_u32 s59, s59, 8781824
    v_mov_b32 v59, 0
K1_BP:
    s_mov_b32 s32, s16
    s_and_b32 s33, s17, 0xffff
    s_mov_b32 s34, 60000
    s_mov_b32 s35, 0x00020000
    s_mov_b32 s68, s48
    s_and_b32 s69, s49, 0xffff
    s_mov_b32 s70, 128
    s_mov_b32 s71, 0x00020000
    s_and_b32 s56, s52, 1
    v_bfe_u32 v12, v7, 2, 2
    v_lshrrev_b32 v13, 5, v7
    v_lshl_add_u32 v12, v13, 3, v12
    v_lshlrev_b32 v12, 7, v12
    v_bfe_u32 v14, v7, 4, 1
    v_lshl_add_u32 v12, v14, 5, v12
    v_and_b32 v14, 3, v7
    v_lshl_add_u32 v12, v14, 3, v12
    s_lshl_b32 s57, s56, 6
    s_add_u32 s58, s57, 137984
    v_add_u32 v12, s58, v12
    v_and_b32 v14, 31, v7
    v_lshlrev_b32 v14, 7, v14
    v_add_u32 v14, 78080, v14
    v_and_b32 v15, 7, v7
    v_xor_b32 v15, v15, v13
    v_xor_b32 v9, 2, v15
    v_xor_b32 v10, 4, v15
    v_xor_b32 v11, 6, v15
    v_lshl_add_u32 v8, v15, 4, v14
    v_lshl_add_u32 v9, v9, 4, v14
    v_lshl_add_u32 v10, v10, 4, v14
    v_lshl_add_u32 v11, v11, 4, v14
    v_and_b32 v14, 31, v7
    v_mul_u32_u24 v14, 144, v14
    v_lshl_add_u32 v14, v13, 3, v14
    s_add_u32 s58, s57, 129792
    v_add_u32 v14, s58, v14
    s_mov_b32 s58, 0xbfb8aa3b
    s_barrier
    s_cmp_eq_u32 s52, 11
    s_cbranch_scc1 K1_BP1
    global_load_dword v51, v4, s[96:97] sc0 sc1
K1_BP1:
    s_barrier
    ds_read_b64_tr_b16 v[16:17], v12 offset:0
    ds_read_b64_tr_b16 v[18:19], v12 offset:512
    ds_read_b64_tr_b16 v[20:21], v12 offset:2048
    ds_read_b64_tr_b16 v[22:23], v12 offset:2560
    ds_read_b64_tr_b16 v[24:25], v12 offset:4096
    ds_read_b64_tr_b16 v[26:27], v12 offset:4608
    ds_read_b64_tr_b16 v[28:29], v12 offset:6144
    ds_read_b64_tr_b16 v[30:31], v12 offset:6656
    s_barrier
    ds_read_b128 v[68:71], v8 offset:0
    ds_read_b128 v[72:75], v9 offset:0
    ds_read_b128 v[76:79], v10 offset:0
    ds_read_b128 v[80:83], v11 offset:0
    ds_read_b128 v[84:87], v8 offset:4096
    ds_read_b128 v[88:91], v9 offset:4096
    ds_read_b128 v[92:95], v10 offset:4096
    ds_read_b128 v[96:99], v11 offset:4096
    s_waitcnt lgkmcnt(7)
    v_mfma_f32_32x32x16_bf16 v[100:115], v[16:19], v[68:71], 0
    s_waitcnt lgkmcnt(6)
    v_mfma_f32_32x32x16_bf16 v[100:115], v[20:23], v[72:75], v[100:115]
    s_waitcnt lgkmcnt(5)
    v_mfma_f32_32x32x16_bf16 v[100:115], v[24:27], v[76:79], v[100:115]
    s_waitcnt lgkmcnt(4)
    v_mfma_f32_32x32x16_bf16 v[100:115], v[28:31], v[80:83], v[100:115]
    s_waitcnt lgkmcnt(3)
    v_mfma_f32_32x32x16_bf16 v[116:131], v[16:19], v[84:87], 0
    s_waitcnt lgkmcnt(2)
    v_mfma_f32_32x32x16_bf16 v[116:131], v[20:23], v[88:91], v[116:131]
    s_waitcnt lgkmcnt(1)
    v_mfma_f32_32x32x16_bf16 v[116:131], v[24:27], v[92:95], v[116:131]
    s_waitcnt lgkmcnt(0)
    v_mfma_f32_32x32x16_bf16 v[116:131], v[28:31], v[96:99], v[116:131]
    s_nop 3
    v_mul_f32 v100, s58, v100
    v_mul_f32 v101, s58, v101
    v_mul_f32 v102, s58, v102
    v_mul_f32 v103, s58, v103
    v_mul_f32 v104, s58, v104
    v_mul_f32 v105, s58, v105
    v_mul_f32 v106, s58, v106
    v_mul_f32 v107, s58, v107
    v_mul_f32 v108, s58, v108
    v_mul_f32 v109, s58, v109
    v_mul_f32 v110, s58, v110
    v_mul_f32 v111, s58, v111
    v_mul_f32 v112, s58, v112
    v_mul_f32 v113, s58, v113
    v_mul_f32 v114, s58, v114
    v_mul_f32 v115, s58, v115
    v_cvt_pk_bf16_f32 v100, v100, v101
    v_cvt_pk_bf16_f32 v101, v102, v103
    v_cvt_pk_bf16_f32 v102, v104, v105
    v_cvt_pk_bf16_f32 v103, v106, v107
    v_cvt_pk_bf16_f32 v104, v108, v109
    v_cvt_pk_bf16_f32 v105, v110, v111
    v_cvt_pk_bf16_f32 v106, v112, v113
    v_cvt_pk_bf16_f32 v107, v114, v115
    ds_write_b64 v14, v[100:101] offset:0
    ds_write_b64 v14, v[102:103] offset:16
    ds_write_b64 v14, v[104:105] offset:32
    ds_write_b64 v14, v[106:107] offset:48
    v_mul_f32 v116, s58, v116
    v_mul_f32 v117, s58, v117
    v_mul_f32 v118, s58, v118
    v_mul_f32 v119, s58, v119
    v_mul_f32 v120, s58, v120
    v_mul_f32 v121, s58, v121
    v_mul_f32 v122, s58, v122
    v_mul_f32 v123, s58, v123
    v_mul_f32 v124, s58, v124
    v_mul_f32 v125, s58, v125
    v_mul_f32 v126, s58, v126
    v_mul_f32 v127, s58, v127
    v_mul_f32 v128, s58, v128
    v_mul_f32 v129, s58, v129
    v_mul_f32 v130, s58, v130
    v_mul_f32 v131, s58, v131
    v_cvt_pk_bf16_f32 v116, v116, v117
    v_cvt_pk_bf16_f32 v117, v118, v119
    v_cvt_pk_bf16_f32 v118, v120, v121
    v_cvt_pk_bf16_f32 v119, v122, v123
    v_cvt_pk_bf16_f32 v120, v124, v125
    v_cvt_pk_bf16_f32 v121, v126, v127
    v_cvt_pk_bf16_f32 v122, v128, v129
    v_cvt_pk_bf16_f32 v123, v130, v131
    s_mov_b32 exec_lo, 0xff
    s_mov_b32 exec_hi, 0xff
    ds_write_b64 v14, v[116:117] offset:4608
    ds_write_b64 v14, v[118:119] offset:4624
    ds_write_b64 v14, v[120:121] offset:4640
    ds_write_b64 v14, v[122:123] offset:4656
    s_mov_b64 exec, -1
    s_cmp_eq_u32 s52, 11
    s_cbranch_scc1 K1_AUXC
K1_TOKP:
    s_waitcnt vmcnt(0)
    v_readfirstlane_b32 s54, v51
    s_cmp_lg_u32 s54, 0
    s_cbranch_scc1 K1_TOKG
    s_sub_u32 s89, s89, 1
    s_cbranch_scc1 K1_TOKG
    s_sleep 2
    global_load_dword v51, v4, s[96:97] sc0 sc1
    s_branch K1_TOKP
K1_TOKG:
    v_mov_b32 v50, 163456
    ds_write_b32 v50, v51
    v_mov_b32_dpp v53, v52 quad_perm:[1,0,3,2] row_mask:0xf bank_mask:0xf
    s_waitcnt lgkmcnt(0)
    s_barrier
    s_cmp_ge_u32 s2, 128
    s_cbranch_scc1 K1_NOWH
    s_mov_b32 exec_lo, 0x55555555
    s_mov_b32 exec_hi, 0x55555555
    v_lshl_or_b32 v52, v53, 16, v52
    buffer_store_dword v52, v48, s[44:47], s60 offen sc1
    s_mov_b64 exec, -1
K1_NOWH:
    s_mov_b32 m0, 146176
    s_movk_i32 s76, 16384
    buffer_load_dwordx4 v49, s[36:39], 0 offen offset:0 lds
    buffer_load_dwordx4 v49, s[36:39], 0 offen offset:1024 lds
    buffer_load_dwordx4 v49, s[36:39], 0 offen offset:2048 lds
    buffer_load_dwordx4 v49, s[36:39], 0 offen offset:3072 lds
    s_mov_b32 m0, 150272
    s_nop 0
    buffer_load_dwordx4 v49, s[36:39], s75 offen offset:0 lds
    buffer_load_dwordx4 v49, s[36:39], s75 offen offset:1024 lds
    buffer_load_dwordx4 v49, s[36:39], s75 offen offset:2048 lds
    buffer_load_dwordx4 v49, s[36:39], s75 offen offset:3072 lds
    buffer_load_ushort v60, v48, s[36:39], s76 offen offset:0
    buffer_load_ushort v61, v48, s[36:39], s76 offen offset:128
    buffer_load_ushort v62, v48, s[36:39], s76 offen offset:256
    buffer_load_ushort v63, v48, s[36:39], s76 offen offset:384
    buffer_load_ushort v64, v48, s[36:39], s76 offen offset:512
    buffer_load_ushort v65, v48, s[68:71], 0 offen
    s_branch K1_PUB
K1_AUXC:
    v_lshrrev_b32 v14, 3, v7
    v_lshl_add_u32 v14, v14, 4, v49
    v_add_u32 v14, 129792, v14
    s_add_u32 s77, s77, 10092544
    s_add_u32 s78, s77, 4096
    s_waitcnt lgkmcnt(0)
    s_barrier
    ds_read_b128 v[68:71], v14 offset:0
    ds_read_b128 v[72:75], v14 offset:1152
    ds_read_b128 v[76:79], v14 offset:2304
    ds_read_b128 v[80:83], v14 offset:3456
    ds_read_b128 v[84:87], v14 offset:4608
    s_waitcnt vmcnt(0)
    v_lshlrev_b32 v56, 16, v56
    v_lshlrev_b32 v57, 16, v57
    v_lshlrev_b32 v58, 16, v58
    s_waitcnt lgkmcnt(4)
    buffer_store_dwordx4 v[68:71], v49, s[44:47], s77 offen offset:0 sc1
    s_waitcnt lgkmcnt(3)
    buffer_store_dwordx4 v[72:75], v49, s[44:47], s77 offen offset:1024 sc1
    s_waitcnt lgkmcnt(2)
    buffer_store_dwordx4 v[76:79], v49, s[44:47], s77 offen offset:2048 sc1
    s_waitcnt lgkmcnt(1)
    buffer_store_dwordx4 v[80:83], v49, s[44:47], s77 offen offset:3072 sc1
    s_cmp_eq_u32 s79, 40
    s_cselect_b32 exec_hi, -1, 0xffffff
    s_waitcnt lgkmcnt(0)
    buffer_store_dwordx4 v[84:87], v49, s[44:47], s78 offen sc1
    s_cmp_ge_u32 s2, 250
    s_cbranch_scc1 K1_AUXE
    s_mov_b32 exec_hi, 0xff
    buffer_store_dwordx4 v[56:59], v49, s[44:47], s59 offen sc1
K1_AUXE:
    s_mov_b64 exec, -1
    buffer_load_ushort v60, v51, s[32:35], s76 offen
    buffer_load_ushort v61, v51, s[32:35], s76 offen offset:2
    buffer_load_ushort v62, v51, s[32:35], s76 offen offset:4
    s_branch K1_PUB
K_HOT_END:
K2_FL_RMW:
    ds_read2st64_b32 v[92:93], v139 offset0:12 offset1:13
    ds_read2st64_b32 v[94:95], v139 offset0:14 offset1:15
    ds_read2st64_b32 v[96:97], v143 offset0:0 offset1:1
    ds_read2st64_b32 v[98:99], v143 offset0:2 offset1:3
    s_waitcnt lgkmcnt(0)
    v_add_f32 v44, v44, v92
    v_add_f32 v48, v48, v93
    v_add_f32 v52, v52, v94
    v_add_f32 v56, v56, v95
    v_add_f32 v60, v60, v96
    v_add_f32 v64, v64, v97
    v_add_f32 v68, v68, v98
    v_add_f32 v72, v72, v99
    s_branch K2_FL_W
K2_FL_RMW2:
    ds_read_b128 v[44:47], v142 offset:0
    ds_read_b128 v[48:51], v142 offset:1024
    ds_read_b128 v[52:55], v142 offset:2048
    s_waitcnt lgkmcnt(0)
    v_add_f32 v92, v92, v44
    v_add_f32 v93, v93, v45
    v_add_f32 v94, v94, v46
    v_add_f32 v95, v95, v47
    v_add_f32 v96, v96, v48
    v_add_f32 v97, v97, v49
    v_add_f32 v98, v98, v50
    v_add_f32 v99, v99, v51
    v_add_f32 v100, v100, v52
    v_add_f32 v101, v101, v53
    v_add_f32 v102, v102, v54
    v_add_f32 v103, v103, v55
    s_branch K2_FL_W2
K2_MID_BATCH:
    s_mov_b32 s70, s28
    s_waitcnt lgkmcnt(0)
    s_barrier
K2_RD_TASK:
    s_mul_i32 s71, s70, 52
    s_lshr_b32 s71, s71, 8
    s_mul_i32 s72, s71, 5
    s_sub_u32 s72, s70, s72
    s_lshl_b32 s73, s70, 10
    s_add_u32 s73, s73, 129792
    v_add_u32 v125, s73, v153
    ds_read_b128 v[44:47], v125
    s_mul_i32 s74, s71, 12
    s_lshr_b64 s[74:75], s[4:5], s74
    s_and_b32 s74, s74, 0xfff
    s_lshl_b32 s75, s72, 10
    s_add_u32 s75, s75, 36480
    s_movk_i32 s76, 4160
    s_cmp_eq_u32 s72, 4
    s_cselect_b32 s75, 86400, s75
    s_cselect_b32 s76, 1024, s76
K2_RD_MORE:
    s_cmp_eq_u32 s74, 0
    s_cbranch_scc1 K2_RD_DONE
    s_ff1_i32_b32 s80, s74
    s_bitset0_b32 s74, s80
    s_mul_i32 s80, s80, s76
    s_add_u32 s80, s80, s75
    v_add_u32 v131, s80, v153
    ds_read_b128 v[48:51], v131
    s_waitcnt lgkmcnt(0)
    v_add_f32 v44, v44, v48
    v_add_f32 v45, v45, v49
    v_add_f32 v46, v46, v50
    v_add_f32 v47, v47, v51
    s_branch K2_RD_MORE
K2_RD_DONE:
    s_waitcnt lgkmcnt(0)
    ds_write_b128 v125, v[44:47]
    s_add_u32 s70, s70, 12
    s_cmp_lt_u32 s70, 25
    s_cbranch_scc1 K2_RD_TASK
    s_mov_b32 s31, s43
    s_mov_b32 s46, s24
    s_branch K2_BATCH
K2_SLOW:
    s_setprio 0
    s_waitcnt vmcnt(0)
K2_BATCH:
    s_lshl_b32 s64, s2, 12
    s_add_u32 s64, s64, 7733248
    v_and_b32 v56, 255, v0
    v_lshlrev_b32 v56, 4, v56
    v_and_b32 v148, 63, v0
    buffer_load_dwordx4 v[36:39], v56, s[12:15], s64 offen sc1
    s_lshl_b32 s64, s2, 4
    s_add_u32 s64, s64, 9043968
    v_and_b32 v56, 31, v0
    v_bfe_u32 v57, v0, 5, 3
    v_lshlrev_b32 v56, 15, v56
    v_lshl_add_u32 v56, v57, 12, v56
    buffer_load_dwordx4 v[58:61], v56, s[12:15], s64 offen sc1
    s_waitcnt vmcnt(0) lgkmcnt(0)
    s_barrier
    v_and_b32 v50, 0xffff, v58
    v_lshrrev_b32 v63, 16, v58
    v_cmp_lt_u32 vcc, 32, v63
    v_and_b32 v40, 0xffff, v36
    v_lshrrev_b32 v41, 16, v36
    v_and_b32 v42, 0xffff, v37
    v_lshrrev_b32 v43, 16, v37
    v_and_b32 v44, 0xffff, v38
    v_bfe_u32 v56, v60, 0, 6
    v_cndmask_b32 v40, v56, v40, vcc
    v_bfe_u32 v56, v60, 6, 6
    v_cndmask_b32 v41, v56, v41, vcc
    v_bfe_u32 v56, v60, 12, 6
    v_cndmask_b32 v42, v56, v42, vcc
    v_bfe_u32 v56, v60, 18, 6
    v_cndmask_b32 v43, v56, v43, vcc
    v_bfe_u32 v56, v60, 24, 6
    v_cndmask_b32 v44, v56, v44, vcc
    v_cmp_le_u32 vcc, s31, v0
    v_add_u32 v51, v50, v40
    v_add_u32 v52, v51, v41
    v_add_u32 v53, v52, v42
    v_add_u32 v54, v53, v43
    v_cndmask_b32 v40, 0, v40, vcc
    v_cndmask_b32 v41, 0, v41, vcc
    v_cndmask_b32 v42, 0, v42, vcc
    v_cndmask_b32 v43, 0, v43, vcc
    v_cndmask_b32 v44, 0, v44, vcc
    v_mov_b32 v45, v40
    v_mov_b32 v46, v41
    v_mov_b32 v47, v42
    v_mov_b32 v48, v43
    v_mov_b32 v49, v44
    s_nop 1
    v_add_u32_dpp v45, v45, v45 row_shr:1 row_mask:0xf bank_mask:0xf bound_ctrl:0
    v_add_u32_dpp v46, v46, v46 row_shr:1 row_mask:0xf bank_mask:0xf bound_ctrl:0
    v_add_u32_dpp v47, v47, v47 row_shr:1 row_mask:0xf bank_mask:0xf bound_ctrl:0
    v_add_u32_dpp v48, v48, v48 row_shr:1 row_mask:0xf bank_mask:0xf bound_ctrl:0
    v_add_u32_dpp v49, v49, v49 row_shr:1 row_mask:0xf bank_mask:0xf bound_ctrl:0
    v_add_u32_dpp v45, v45, v45 row_shr:2 row_mask:0xf bank_mask:0xf bound_ctrl:0
    v_add_u32_dpp v46, v46, v46 row_shr:2 row_mask:0xf bank_mask:0xf bound_ctrl:0
    v_add_u32_dpp v47, v47, v47 row_shr:2 row_mask:0xf bank_mask:0xf bound_ctrl:0
    v_add_u32_dpp v48, v48, v48 row_shr:2 row_mask:0xf bank_mask:0xf bound_ctrl:0
    v_add_u32_dpp v49, v49, v49 row_shr:2 row_mask:0xf bank_mask:0xf bound_ctrl:0
    v_add_u32_dpp v45, v45, v45 row_shr:4 row_mask:0xf bank_mask:0xf bound_ctrl:0
    v_add_u32_dpp v46, v46, v46 row_shr:4 row_mask:0xf bank_mask:0xf bound_ctrl:0
    v_add_u32_dpp v47, v47, v47 row_shr:4 row_mask:0xf bank_mask:0xf bound_ctrl:0
    v_add_u32_dpp v48, v48, v48 row_shr:4 row_mask:0xf bank_mask:0xf bound_ctrl:0
    v_add_u32_dpp v49, v49, v49 row_shr:4 row_mask:0xf bank_mask:0xf bound_ctrl:0
    v_add_u32_dpp v45, v45, v45 row_shr:8 row_mask:0xf bank_mask:0xf bound_ctrl:0
    v_add_u32_dpp v46, v46, v46 row_shr:8 row_mask:0xf bank_mask:0xf bound_ctrl:0
    v_add_u32_dpp v47, v47, v47 row_shr:8 row_mask:0xf bank_mask:0xf bound_ctrl:0
    v_add_u32_dpp v48, v48, v48 row_shr:8 row_mask:0xf bank_mask:0xf bound_ctrl:0
    v_add_u32_dpp v49, v49, v49 row_shr:8 row_mask:0xf bank_mask:0xf bound_ctrl:0
    v_add_u32_dpp v45, v45, v45 row_bcast:15 row_mask:0xa bank_mask:0xf
    v_add_u32_dpp v46, v46, v46 row_bcast:15 row_mask:0xa bank_mask:0xf
    v_add_u32_dpp v47, v47, v47 row_bcast:15 row_mask:0xa bank_mask:0xf
    v_add_u32_dpp v48, v48, v48 row_bcast:15 row_mask:0xa bank_mask:0xf
    v_add_u32_dpp v49, v49, v49 row_bcast:15 row_mask:0xa bank_mask:0xf
    v_add_u32_dpp v45, v45, v45 row_bcast:31 row_mask:0xc bank_mask:0xf
    v_add_u32_dpp v46, v46, v46 row_bcast:31 row_mask:0xc bank_mask:0xf
    v_add_u32_dpp v47, v47, v47 row_bcast:31 row_mask:0xc bank_mask:0xf
    v_add_u32_dpp v48, v48, v48 row_bcast:31 row_mask:0xc bank_mask:0xf
    v_add_u32_dpp v49, v49, v49 row_bcast:31 row_mask:0xc bank_mask:0xf
    s_cmp_gt_u32 s28, 3
    s_cbranch_scc1 K2_B1
    s_lshl_b32 s55, s28, 2
    s_add_u32 s55, s55, 163072
    v_mov_b32 v56, s55
    s_mov_b32 exec_lo, 0
    s_mov_b32 exec_hi, 0x80000000
    ds_write2_b32 v56, v45, v46 offset0:0 offset1:4
    ds_write2_b32 v56, v47, v48 offset0:8 offset1:12
    ds_write_b32 v56, v49 offset:64
    s_mov_b64 exec, -1
K2_B1:
    v_and_b32 v56, 7, v0
    v_lshlrev_b32 v56, 4, v56
    v_add_u32 v56, 163072, v56
    s_waitcnt lgkmcnt(0)
    s_barrier
    ds_read_b128 v[56:59], v56
    s_waitcnt lgkmcnt(0)
    v_add_u32 v57, v57, v56
    v_add_u32 v58, v58, v57
    s_cmp_eq_u32 s28, 0
    s_cbranch_scc1 K2_B2
    s_cmp_eq_u32 s28, 1
    s_cbranch_scc1 K2_B1B
    v_mov_b32 v56, v57
    s_cmp_eq_u32 s28, 2
    s_cbranch_scc1 K2_B1B
    v_mov_b32 v56, v58
K2_B1B:
    s_nop 0
    v_readlane_b32 s60, v56, 0
    v_readlane_b32 s61, v56, 1
    v_readlane_b32 s62, v56, 2
    v_readlane_b32 s63, v56, 3
    v_readlane_b32 s64, v56, 4
    s_nop 1
    v_add_u32 v45, s60, v45
    v_add_u32 v46, s61, v46
    v_add_u32 v47, s62, v47
    v_add_u32 v48, s63, v48
    v_add_u32 v49, s64, v49
K2_B2:
    s_cmp_gt_u32 s28, 3
    s_cbranch_scc1 K2_SL1
    v_add3_u32 v56, v45, v46, v47
    v_add3_u32 v56, v56, v48, v49
    v_cmp_le_u32 s[54:55], s31, v0
    v_cmp_ge_u32 vcc, 2885, v56
    s_and_b64 s[54:55], s[54:55], vcc
    s_flbit_i32_b64 s56, s[54:55]
    s_sub_u32 s56, 63, s56
    s_and_b32 s56, s56, 63
    s_lshl_b32 s57, s28, 6
    s_add_u32 s57, s57, s56
    s_add_u32 s57, s57, 1
    s_cmp_eq_u64 s[54:55], 0
    s_cselect_b32 s57, 0, s57
    s_lshl_b64 s[54:55], 1, s56
    s_lshl_b32 s58, s28, 5
    s_add_u32 s58, s58, 163200
    v_mov_b32 v56, s58
    v_mov_b32 v57, s57
    s_mov_b64 exec, s[54:55]
    ds_write2_b32 v56, v45, v46 offset0:0 offset1:1
    ds_write2_b32 v56, v47, v48 offset0:2 offset1:3
    ds_write2_b32 v56, v49, v57 offset0:4 offset1:5
    s_mov_b64 exec, -1
K2_SL1:
    v_and_b32 v56, 31, v0
    v_lshlrev_b32 v56, 2, v56
    v_add_u32 v56, 163200, v56
    s_waitcnt lgkmcnt(0)
    s_barrier
    ds_read_b32 v56, v56
    s_waitcnt lgkmcnt(0)
    v_readlane_b32 s60, v56, 0
    v_readlane_b32 s61, v56, 1
    v_readlane_b32 s62, v56, 2
    v_readlane_b32 s63, v56, 3
    v_readlane_b32 s64, v56, 4
    v_readlane_b32 s65, v56, 5
    s_nop 1
    s_cmp_lg_u32 s65, 0
    s_cselect_b32 s38, s60, s38
    s_cselect_b32 s39, s61, s39
    s_cselect_b32 s40, s62, s40
    s_cselect_b32 s41, s63, s41
    s_cselect_b32 s42, s64, s42
    s_cselect_b32 s43, s65, s43
    v_readlane_b32 s60, v56, 8
    v_readlane_b32 s61, v56, 9
    v_readlane_b32 s62, v56, 10
    v_readlane_b32 s63, v56, 11
    v_readlane_b32 s64, v56, 12
    v_readlane_b32 s65, v56, 13
    s_nop 1
    s_cmp_lg_u32 s65, 0
    s_cselect_b32 s38, s60, s38
    s_cselect_b32 s39, s61, s39
    s_cselect_b32 s40, s62, s40
    s_cselect_b32 s41, s63, s41
    s_cselect_b32 s42, s64, s42
    s_cselect_b32 s43, s65, s43
    v_readlane_b32 s60, v56, 16
    v_readlane_b32 s61, v56, 17
    v_readlane_b32 s62, v56, 18
    v_readlane_b32 s63, v56, 19
    v_readlane_b32 s64, v56, 20
    v_readlane_b32 s65, v56, 21
    s_nop 1
    s_cmp_lg_u32 s65, 0
    s_cselect_b32 s38, s60, s38
    s_cselect_b32 s39, s61, s39
    s_cselect_b32 s40, s62, s40
    s_cselect_b32 s41, s63, s41
    s_cselect_b32 s42, s64, s42
    s_cselect_b32 s43, s65, s43
    v_readlane_b32 s60, v56, 24
    v_readlane_b32 s61, v56, 25
    v_readlane_b32 s62, v56, 26
    v_readlane_b32 s63, v56, 27
    v_readlane_b32 s64, v56, 28
    v_readlane_b32 s65, v56, 29
    s_nop 1
    s_cmp_lg_u32 s65, 0
    s_cselect_b32 s38, s60, s38
    s_cselect_b32 s39, s61, s39
    s_cselect_b32 s40, s62, s40
    s_cselect_b32 s41, s63, s41
    s_cselect_b32 s42, s64, s42
    s_cselect_b32 s43, s65, s43
    s_mov_b32 s32, 0
    s_add_u32 s54, s38, 31
    s_lshr_b32 s54, s54, 5
    s_add_u32 s33, s32, s54
    s_add_u32 s54, s39, 31
    s_lshr_b32 s54, s54, 5
    s_add_u32 s34, s33, s54
    s_add_u32 s54, s40, 31
    s_lshr_b32 s54, s54, 5
    s_add_u32 s35, s34, s54
    s_add_u32 s54, s41, 31
    s_lshr_b32 s54, s54, 5
    s_add_u32 s36, s35, s54
    s_add_u32 s54, s42, 31
    s_lshr_b32 s54, s54, 5
    s_add_u32 s37, s36, s54
    s_cmp_gt_u32 s28, 3
    s_cbranch_scc1 K2_B5
    s_lshl_b32 s54, s32, 5
    v_sub_u32 v56, v45, v40
    v_sub_u32 v56, v56, v50
    v_add_u32 v56, s54, v56
    s_lshl_b32 s54, s33, 5
    v_sub_u32 v57, v46, v41
    v_sub_u32 v57, v57, v51
    v_add_u32 v57, s54, v57
    s_lshl_b32 s54, s34, 5
    v_sub_u32 v58, v47, v42
    v_sub_u32 v58, v58, v52
    v_add_u32 v58, s54, v58
    s_lshl_b32 s54, s35, 5
    v_sub_u32 v59, v48, v43
    v_sub_u32 v59, v59, v53
    v_add_u32 v59, s54, v59
    s_lshl_b32 s54, s36, 5
    v_sub_u32 v60, v49, v44
    v_sub_u32 v60, v60, v54
    v_add_u32 v60, s54, v60
    v_mov_b32 v62, v50
    v_lshlrev_b32 v64, 5, v0
    v_add_u32 v64, 36480, v64
    ds_write_b128 v64, v[56:59]
    ds_write_b128 v64, v[60:63] offset:16
K2_B5:
    s_add_u32 s70, s31, s28
    s_waitcnt lgkmcnt(0)
    s_barrier
K2_SC_POS:
    s_cmp_ge_u32 s70, s43
    s_cbranch_scc1 K2_SC_DONE
    s_lshl_b32 s71, s70, 5
    s_add_u32 s71, s71, 36480
    v_mov_b32 v56, s71
    ds_read_b64 v[58:59], v56 offset:24
    s_and_b32 s72, s70, 31
    s_lshl_b32 s72, s72, 3
    s_lshr_b32 s73, s70, 5
    s_add_u32 s72, s72, s73
    s_mul_i32 s72, s72, 30080
    v_mov_b32 v57, v148
    s_waitcnt lgkmcnt(0)
K2_SC_IN:
    v_cmp_lt_u32 vcc, v57, v59
    v_add_u32 v60, v57, v58
    v_mul_u32_u24 v61, 12, v60
    s_and_saveexec_b64 s[74:75], vcc
    s_cbranch_execz K2_SC_NEXT
    buffer_load_dwordx3 v[36:38], v61, s[12:15], s72 offen sc1
    s_waitcnt vmcnt(0)
    v_and_b32 v61, 7, v36
    v_lshl_add_u32 v61, v61, 2, v56
    ds_read_b32 v61, v61
    s_waitcnt lgkmcnt(0)
    v_add_u32 v61, v61, v60
    v_mul_u32_u24 v61, 12, v61
    ds_write_b32 v61, v36 offset:0
    ds_write2_b32 v61, v37, v38 offset0:1 offset1:2
    s_mov_b64 exec, -1
    v_add_u32 v57, 64, v57
    s_branch K2_SC_IN
K2_SC_NEXT:
    s_mov_b64 exec, -1
    s_add_u32 s70, s70, 12
    s_branch K2_SC_POS
K2_SC_DONE:
    s_mul_i32 s54, s37, 5462
    s_lshr_b32 s54, s54, 16
    s_mul_i32 s55, s54, 12
    s_sub_u32 s55, s37, s55
    s_sub_u32 s55, 12, s55
    s_mul_i32 s44, s28, s54
    s_max_u32 s45, s28, s55
    s_sub_u32 s45, s45, s55
    s_add_u32 s44, s44, s45
    s_add_u32 s45, s44, s54
    s_cmp_ge_u32 s28, s55
    s_addc_u32 s45, s45, 0
    s_mul_i32 s54, s44, 384
    v_and_b32 v167, 31, v0
    v_mul_u32_u24 v167, 12, v167
    v_add_u32 v167, s54, v167
    v_lshrrev_b32 v166, 3, v148
    v_mul_u32_u24 v166, 48, v166
    v_add_u32 v166, s54, v166
    s_cmp_lg_u32 s28, 11
    s_cbranch_scc1 K2_CP_DONE
    v_mov_b32 v133, 64
    v_and_b32 v134, 31, v0
    s_lshl_b32 s54, s32, 5
    s_add_u32 s54, s54, s38
    s_lshl_b32 s55, s33, 5
    s_add_u32 s55, s55, s39
    s_lshl_b32 s56, s33, 5
    s_lshl_b32 s57, s34, 5
    v_add_u32 v132, s54, v134
    v_add_u32 v135, s55, v134
    v_cmp_gt_u32 vcc, s56, v132
    v_cmp_gt_u32 s[58:59], s57, v135
    v_cndmask_b32 v132, v132, v135, s[52:53]
    v_mul_u32_u24 v132, 12, v132
    s_mov_b32 exec_lo, vcc_lo
    s_mov_b32 exec_hi, s59
    ds_write_b32 v132, v133 offset:0
    ds_write2_b32 v132, v2, v2 offset0:1 offset1:2
    s_mov_b64 exec, -1
    s_lshl_b32 s54, s34, 5
    s_add_u32 s54, s54, s40
    s_lshl_b32 s55, s35, 5
    s_add_u32 s55, s55, s41
    s_lshl_b32 s56, s35, 5
    s_lshl_b32 s57, s36, 5
    v_add_u32 v132, s54, v134
    v_add_u32 v135, s55, v134
    v_cmp_gt_u32 vcc, s56, v132
    v_cmp_gt_u32 s[58:59], s57, v135
    v_cndmask_b32 v132, v132, v135, s[52:53]
    v_mul_u32_u24 v132, 12, v132
    s_mov_b32 exec_lo, vcc_lo
    s_mov_b32 exec_hi, s59
    ds_write_b32 v132, v133 offset:0
    ds_write2_b32 v132, v2, v2 offset0:1 offset1:2
    s_mov_b64 exec, -1
    s_lshl_b32 s54, s36, 5
    s_add_u32 s54, s54, s42
    s_lshl_b32 s55, s36, 5
    s_add_u32 s55, s55, s42
    s_lshl_b32 s56, s37, 5
    s_lshl_b32 s57, s37, 5
    v_add_u32 v132, s54, v134
    v_add_u32 v135, s55, v134
    v_cmp_gt_u32 vcc, s56, v132
    v_cmp_gt_u32 s[58:59], s57, v135
    v_cndmask_b32 v132, v132, v135, s[52:53]
    v_mul_u32_u24 v132, 12, v132
    s_mov_b32 exec_lo, vcc_lo
    s_mov_b32 exec_hi, s59
    ds_write_b32 v132, v133 offset:0
    ds_write2_b32 v132, v2, v2 offset0:1 offset1:2
    s_mov_b64 exec, -1
    s_branch K2_CP_DONE
.section .rodata,"a"
.p2align 6
.amdhsa_kernel standalone__cheap_equivariant_egnn__graph_kernel
  .amdhsa_next_free_vgpr 168
  .amdhsa_next_free_sgpr 100
  .amdhsa_accum_offset 168
  .amdhsa_group_segment_fixed_size 0
  .amdhsa_kernarg_size 88
  .amdhsa_user_sgpr_count 2
  .amdhsa_user_sgpr_kernarg_segment_ptr 1
  .amdhsa_system_sgpr_workgroup_id_x 1
.end_amdhsa_kernel
```
